```python
import torch

def _softmax(x, axis=-1):
    return torch.softmax(x, dim=axis)
def _gelu(x):
    return torch.nn.functional.gelu(x, approximate="tanh")
def _silu(x):
    return torch.nn.functional.silu(x)
def _sigmoid(x):
    return torch.sigmoid(x)
def _layernorm(x, axis=-1, eps=1e-5):
    m = x.mean(dim=axis, keepdim=True)
    v = x.var(dim=axis, keepdim=True, unbiased=False)
    return (x - m) / torch.sqrt(v + eps)
def _scatter_add(tgt, idx, src, axis=0):
    return tgt.clone().index_add_(axis, idx, src)
def _segment_sum(src, seg, n):
    out = torch.zeros((n,) + src.shape[1:], dtype=src.dtype)
    return out.index_add_(0, seg, src)
def _pad(x, pw):
    flat = tuple(v for pair in reversed(pw) for v in pair)
    return torch.nn.functional.pad(x, flat)

kernel_name = 'parallel_sum__linear_kernel_hedgehog__mixer_token_mlp__prompt'

def setup_inputs():

    _w = (lambda a: (lambda t: t.to(torch.bfloat16) if t.is_floating_point() else t)(torch.as_tensor(a)))
    def _A_setup():
        B, S, D, H = 1, 2048, 448, 16
        Dh = D // H
        return {
            "x": _w((lambda *s: torch.randn(*s, dtype=torch.bfloat16) * 0.05)(B, S, D)),
            "wqkv": _w((lambda *s: torch.randn(*s, dtype=torch.bfloat16) * 0.2)(D, 3 * D)),
            "w_phi": _w((lambda *s: torch.randn(*s, dtype=torch.bfloat16) * 0.2)(H, Dh, Dh) * (Dh ** -0.5)),
            "wo": _w((lambda *s: torch.randn(*s, dtype=torch.bfloat16) * 0.05)(D, D)),
        }
    _A_in = _A_setup()

    def _B_setup():
        B, S, D, F = 1, 2048, 448, 1792
        return {
            "x": _w((lambda *s: torch.randn(*s, dtype=torch.bfloat16) * 0.05)(B, S, D)),
            "w1": _w((lambda *s: torch.randn(*s, dtype=torch.bfloat16) * 0.8)(S, F) * (S ** -0.5)),
            "b1": _w((lambda *s: torch.randn(*s, dtype=torch.bfloat16) * 3.2)(F) * 0.02),
            "w2": _w((lambda *s: torch.randn(*s, dtype=torch.bfloat16) * 0.4)(F, S) * (F ** -0.5)),
            "b2": _w((lambda *s: torch.randn(*s, dtype=torch.bfloat16) * 1.6)(S) * 0.02),
        }
    _B_in = _B_setup()

    return {
        "A_x": _A_in["x"],
        "A_wqkv": _A_in["wqkv"],
        "A_w_phi": _A_in["w_phi"],
        "A_wo": _A_in["wo"],
        "B_x": _B_in["x"],
        "B_w1": _B_in["w1"],
        "B_b1": _B_in["b1"],
        "B_w2": _B_in["w2"],
        "B_b2": _B_in["b2"],
    }

def reference(A_x, A_wqkv, A_w_phi, A_wo, B_x, B_w1, B_b1, B_w2, B_b2):
    def _A_ref(x, wqkv, w_phi, wo):
        B, S, D = x.shape
        H = 16; Dh = D // H
        qkv = (lambda x, *d: x.permute(*d))((x @ wqkv).reshape(B, S, 3, H, Dh), 2, 0, 3, 1, 4)
        q, k, v = qkv[0], qkv[1], qkv[2]
        pq = torch.einsum("bhsd,hdf->bhsf", q, w_phi)
        pk = torch.einsum("bhsd,hdf->bhsf", k, w_phi)
        phi_q = torch.concatenate([_softmax(pq, axis=-1), _softmax(-pq, axis=-1)], axis=-1)
        phi_k = torch.concatenate([_softmax(pk, axis=-1), _softmax(-pk, axis=-1)], axis=-1)
        kv = torch.einsum("bhsf,bhsd->bhfd", phi_k, v)
        z  = torch.einsum("bhsf->bhf", phi_k)
        num = torch.einsum("bhqf,bhfd->bhqd", phi_q, kv)
        den = torch.einsum("bhqf,bhf->bhq", phi_q, z)[..., None] + 1e-6
        o = num / den
        return (lambda x, *d: x.permute(*d))(o, 0, 2, 1, 3).reshape(B, S, D) @ wo

    def _B_ref(x, w1, b1, w2, b2):
        B, S, D = x.shape
        h = _layernorm(x, axis=-1)
        u = torch.einsum("bsd,sf->bdf", h, w1) + b1
        u = _gelu(u)
        y = torch.einsum("bdf,fs->bds", u, w2) + b2
        return (lambda x, *d: x.permute(*d))(y, 0, 2, 1)

    x = A_x
    xn = _layernorm(x, axis=-1)
    return x + _A_ref(xn, A_wqkv, A_w_phi, A_wo) + _B_ref(xn, B_w1, B_b1, B_w2, B_b2)
```

```asm
; @launch grid=(512,1,1) block=(256,1,1) lds=81920
.amdgcn_target "amdgcn-amd-amdhsa--gfx950"
.text
.globl parallel_sum__linear_kernel_hedgehog__mixer_token_mlp__prompt_kernel
.p2align 8
.type parallel_sum__linear_kernel_hedgehog__mixer_token_mlp__prompt_kernel,@function
parallel_sum__linear_kernel_hedgehog__mixer_token_mlp__prompt_kernel:
    s_cmp_ge_u32 s2, 512
    s_cbranch_scc1 K_END
    s_load_dwordx8 s[4:11], s[0:1], 0
    s_load_dwordx4 s[28:31], s[0:1], 80
    s_load_dwordx4 s[40:43], s[0:1], 40
    s_load_dwordx4 s[52:55], s[0:1], 56
    s_load_dwordx2 s[12:13], s[0:1], 72
    v_lshrrev_b32 v1, 6, v0
    s_and_b32 s56, s2, 7
    v_readfirstlane_b32 s14, v1
    s_bfe_u32 s57, s2, 0x50003
    s_cmp_lt_u32 s2, 256
    s_cbranch_scc1 ROLE_A
    s_cmp_ge_u32 s57, 28
    s_cbranch_scc1 K_P
    s_cmp_lg_u32 s56, 7
    s_cbranch_scc1 ROLE_G
    s_add_u32 s36, s57, 32
    s_lshl_b32 s37, s57, 2
    s_add_u32 s37, s37, s14
    s_cmp_lt_u32 s37, 83
    s_cbranch_scc1 ROLE_P
    s_cmp_lg_u32 s14, 3
    s_cbranch_scc1 ROLE_P
    s_sub_u32 s37, 27, s57
    s_lshl_b32 s38, s37, 14
    v_and_b32 v6, 63, v0
    v_lshlrev_b32 v6, 8, v6
    v_add_u32 v6, 0x840000, v6
    v_add_u32 v6, s38, v6
    v_mov_b32 v7, 0
    s_waitcnt lgkmcnt(0)
    global_store_dword v6, v7, s[30:31] sc1
    s_cmp_lg_u32 s37, 0
    s_cbranch_scc1 ROLE_P
    s_mov_b32 s62, 1
    s_waitcnt vmcnt(0)
    s_atomic_add s62, s[28:29], 0x0
    s_branch ROLE_P
K_P:
    s_sub_u32 s36, s2, 480
    s_branch ROLE_P
ROLE_A:
    s_lshr_b32 s38, s56, 1
    s_lshl_b32 s38, s38, 2
    s_and_b32 s39, s57, 3
    s_add_u32 s38, s38, s39
    s_and_b32 s39, s56, 1
    s_lshl_b32 s39, s39, 3
    s_lshr_b32 s57, s57, 2
    s_add_u32 s39, s39, s57
    s_lshl_b32 s15, s38, 4
    s_add_u32 s15, s15, s39
    v_and_b32 v253, 31, v0
    v_lshrrev_b32 v2, 5, v0
    s_mul_i32 s20, s15, 7168
    v_min_u32 v4, 27, v253
    v_mul_u32_u24 v3, 896, v2
    v_lshl_add_u32 v3, v4, 5, v3
    v_add_u32 v4, s20, v3
    s_waitcnt lgkmcnt(0)
    global_load_dwordx4 v[8:11], v4, s[4:5]
    global_load_dwordx4 v[12:15], v4, s[4:5] offset:16
    s_branch A_CONT
ROLE_G:
    v_and_b32 v238, 63, v0
    s_mul_i32 s61, s57, 37
    s_lshr_b32 s61, s61, 8
    s_lshl_b32 s66, s56, 2
    s_add_u32 s66, s66, s61
    s_mul_i32 s61, s61, 7
    s_sub_u32 s64, s57, s61
    s_mul_i32 s50, s14, 20480
    s_lshl_b32 s67, s66, 7
    s_lshr_b32 s60, s14, 1
    s_lshl_b32 s60, s60, 6
    s_add_u32 s60, s60, s67
    v_lshrrev_b32 v251, 5, v238
    v_lshlrev_b32 v251, 3, v251
    v_lshrrev_b32 v252, 3, v238
    v_mul_u32_u24 v232, 3584, v252
    v_lshrrev_b32 v253, 2, v238
    v_and_b32 v253, 4, v253
    v_and_b32 v254, 7, v238
    v_xor_b32 v253, v253, v254
    v_lshl_add_u32 v232, v253, 4, v232
    v_add_u32 v232, s67, v232
    v_add_u32 v233, 28672, v232
    s_lshl_b32 s61, s66, 2
    s_add_u32 s51, s61, 0
    s_and_b32 s51, s51, 12
    s_add_u32 s51, s51, s14
    s_add_u32 s15, s61, 4
    s_and_b32 s15, s15, 12
    s_add_u32 s15, s15, s14
    s_add_u32 s59, s61, 8
    s_and_b32 s59, s59, 12
    s_add_u32 s59, s59, s14
    s_add_u32 s3, s61, 12
    s_and_b32 s3, s3, 12
    s_add_u32 s3, s3, s14
    s_mov_b32 s18, 7340032
    s_mov_b32 s19, 0x20000
    s_waitcnt lgkmcnt(0)
    s_mov_b32 s16, s40
    s_and_b32 s17, s41, 0xffff
    s_lshl_b32 s6, s64, 4
    s_cmp_eq_u32 s56, 7
    s_cbranch_scc1 G_SETUP
    s_add_u32 s58, s6, s51
    s_add_u32 m0, s50, 0
    s_mul_i32 s58, s58, 57344
    buffer_load_dwordx4 v232, s[16:19], s58 offen lds
    s_add_u32 m0, s50, 1024
    s_nop 0
    buffer_load_dwordx4 v233, s[16:19], s58 offen lds
    s_add_u32 s58, s6, s15
    s_add_u32 m0, s50, 2048
    s_mul_i32 s58, s58, 57344
    buffer_load_dwordx4 v232, s[16:19], s58 offen lds
    s_add_u32 m0, s50, 3072
    s_nop 0
    buffer_load_dwordx4 v233, s[16:19], s58 offen lds
    s_add_u32 s58, s6, s59
    s_add_u32 m0, s50, 4096
    s_mul_i32 s58, s58, 57344
    buffer_load_dwordx4 v232, s[16:19], s58 offen lds
    s_add_u32 m0, s50, 5120
    s_nop 0
    buffer_load_dwordx4 v233, s[16:19], s58 offen lds
    s_add_u32 s58, s6, s3
    s_add_u32 m0, s50, 6144
    s_mul_i32 s58, s58, 57344
    buffer_load_dwordx4 v232, s[16:19], s58 offen lds
    s_add_u32 m0, s50, 7168
    s_nop 0
    buffer_load_dwordx4 v233, s[16:19], s58 offen lds
    s_branch G_SETUP
A_CONT:
    s_mov_b32 s58, 0x0fffffff
    s_mov_b32 s59, 0x0fffffff
    s_setprio 2
    s_mul_i32 s25, s39, 77824
    s_add_u32 s25, s25, 0x400000
    v_and_b32 v250, 63, v0
    v_bfe_u32 v255, v0, 5, 1
    v_mov_b32 v248, 0
    v_lshlrev_b32 v251, 4, v250
    v_mul_u32_u24 v252, 448, v255
    v_lshl_add_u32 v252, v253, 4, v252
    s_mov_b32 s32, s30
    s_and_b32 s33, s31, 0xffff
    s_mov_b32 s34, 0x1000000
    s_mov_b32 s35, 0x20000
    s_mov_b32 s44, s28
    s_and_b32 s45, s29, 0xffff
    s_mov_b32 s46, 256
    s_mov_b32 s47, 0x20000
    v_lshl_add_u32 v5, v2, 4, v3
    v_bfe_u32 v88, v250, 2, 2
    v_mul_u32_u24 v88, 912, v88
    v_lshrrev_b32 v89, 4, v250
    v_lshl_add_u32 v88, v89, 5, v88
    v_and_b32 v89, 3, v250
    v_lshl_add_u32 v88, v89, 3, v88
    s_lshl_b32 s20, s14, 7
    v_add_u32 v88, s20, v88
    v_lshlrev_b32 v92, 10, v255
    v_lshl_add_u32 v92, v253, 4, v92
    v_and_b32 v89, 7, v250
    v_lshrrev_b32 v90, 3, v250
    s_lshl_b32 s20, s14, 3
    v_add_u32 v90, s20, v90
    v_mul_u32_u24 v91, 896, v89
    v_lshl_add_u32 v91, v90, 4, v91
    v_lshlrev_b32 v89, 4, v89
    v_lshl_add_u32 v89, v90, 9, v89
    s_lshr_b32 s20, s15, 2
    s_mul_i32 s20, s20, 28672
    s_and_b32 s21, s15, 3
    s_lshl_b32 s21, s21, 7
    s_add_u32 s20, s20, s21
    s_lshl_b32 s21, s14, 18
    s_lshr_b32 s22, s15, 1
    s_lshl_b32 s22, s22, 11
    s_add_u32 s21, s21, s22
    s_and_b32 s22, s15, 1
    s_lshl_b32 s22, s22, 9
    s_add_u32 s21, s21, s22
    s_add_u32 s21, s21, 0x200000
    s_cmp_eq_u32 s14, 3
    s_cselect_b32 s23, 0x08000000, 0
    s_add_u32 s22, s21, 1048576
    s_or_b32 s22, s22, s23
    s_add_u32 s24, s20, 16384
    s_or_b32 s24, s24, s23
    s_lshl_b32 s40, s39, 8
    s_add_u32 s40, s40, 0x840000
    s_lshl_b32 s41, s38, 8
    s_add_u32 s41, s41, 0x840000
    s_waitcnt vmcnt(0)
    v_lshlrev_b32 v16, 16, v8
    v_and_b32 v17, 0xffff0000, v8
    v_lshlrev_b32 v18, 16, v9
    v_and_b32 v19, 0xffff0000, v9
    v_lshlrev_b32 v20, 16, v10
    v_and_b32 v21, 0xffff0000, v10
    v_lshlrev_b32 v22, 16, v11
    v_and_b32 v23, 0xffff0000, v11
    v_lshlrev_b32 v24, 16, v12
    v_and_b32 v25, 0xffff0000, v12
    v_lshlrev_b32 v26, 16, v13
    v_and_b32 v27, 0xffff0000, v13
    v_lshlrev_b32 v28, 16, v14
    v_and_b32 v29, 0xffff0000, v14
    v_lshlrev_b32 v30, 16, v15
    v_and_b32 v31, 0xffff0000, v15
    v_pk_add_f32 v[72:73], v[16:17], v[18:19]
    v_pk_add_f32 v[74:75], v[20:21], v[22:23]
    v_pk_add_f32 v[72:73], v[72:73], v[24:25]
    v_pk_add_f32 v[74:75], v[74:75], v[26:27]
    v_pk_add_f32 v[72:73], v[72:73], v[28:29]
    v_pk_add_f32 v[74:75], v[74:75], v[30:31]
    v_pk_add_f32 v[72:73], v[72:73], v[74:75]
    v_add_f32 v72, v72, v73
    v_cndmask_b32 v72, 0, v72, s[58:59]
    s_nop 1
    v_add_f32_dpp v72, v72, v72 quad_perm:[1,0,3,2] row_mask:0xf bank_mask:0xf
    s_nop 1
    v_add_f32_dpp v72, v72, v72 quad_perm:[2,3,0,1] row_mask:0xf bank_mask:0xf
    s_nop 1
    v_add_f32_dpp v72, v72, v72 row_half_mirror row_mask:0xf bank_mask:0xf
    s_nop 1
    v_add_f32_dpp v72, v72, v72 row_mirror row_mask:0xf bank_mask:0xf
    v_mov_b32 v73, v72
    s_nop 1
    v_permlane16_swap_b32 v72, v73
    s_nop 0
    v_add_f32 v72, v72, v73
    v_mul_f32 v72, 0x3b124925, v72
    v_cvt_pk_bf16_f32 v80, v72, v72
    v_lshlrev_b32 v80, 16, v80
    v_pk_add_f32 v[16:17], v[16:17], v[80:81] op_sel_hi:[1,0] neg_lo:[0,1] neg_hi:[0,1]
    v_pk_add_f32 v[18:19], v[18:19], v[80:81] op_sel_hi:[1,0] neg_lo:[0,1] neg_hi:[0,1]
    v_pk_add_f32 v[20:21], v[20:21], v[80:81] op_sel_hi:[1,0] neg_lo:[0,1] neg_hi:[0,1]
    v_pk_add_f32 v[22:23], v[22:23], v[80:81] op_sel_hi:[1,0] neg_lo:[0,1] neg_hi:[0,1]
    v_pk_add_f32 v[24:25], v[24:25], v[80:81] op_sel_hi:[1,0] neg_lo:[0,1] neg_hi:[0,1]
    v_pk_add_f32 v[26:27], v[26:27], v[80:81] op_sel_hi:[1,0] neg_lo:[0,1] neg_hi:[0,1]
    v_pk_add_f32 v[28:29], v[28:29], v[80:81] op_sel_hi:[1,0] neg_lo:[0,1] neg_hi:[0,1]
    v_pk_add_f32 v[30:31], v[30:31], v[80:81] op_sel_hi:[1,0] neg_lo:[0,1] neg_hi:[0,1]
    v_pk_mul_f32 v[76:77], v[16:17], v[16:17]
    v_pk_mul_f32 v[78:79], v[18:19], v[18:19]
    v_pk_fma_f32 v[76:77], v[20:21], v[20:21], v[76:77]
    v_pk_fma_f32 v[78:79], v[22:23], v[22:23], v[78:79]
    v_pk_fma_f32 v[76:77], v[24:25], v[24:25], v[76:77]
    v_pk_fma_f32 v[78:79], v[26:27], v[26:27], v[78:79]
    v_pk_fma_f32 v[76:77], v[28:29], v[28:29], v[76:77]
    v_pk_fma_f32 v[78:79], v[30:31], v[30:31], v[78:79]
    v_pk_add_f32 v[76:77], v[76:77], v[78:79]
    v_add_f32 v76, v76, v77
    v_sub_f32 v72, v72, v80
    v_cndmask_b32 v76, 0, v76, s[58:59]
    s_nop 1
    v_add_f32_dpp v76, v76, v76 quad_perm:[1,0,3,2] row_mask:0xf bank_mask:0xf
    s_nop 1
    v_add_f32_dpp v76, v76, v76 quad_perm:[2,3,0,1] row_mask:0xf bank_mask:0xf
    s_nop 1
    v_add_f32_dpp v76, v76, v76 row_half_mirror row_mask:0xf bank_mask:0xf
    s_nop 1
    v_add_f32_dpp v76, v76, v76 row_mirror row_mask:0xf bank_mask:0xf
    v_mov_b32 v77, v76
    s_nop 1
    v_permlane16_swap_b32 v76, v77
    s_nop 0
    v_add_f32 v76, v76, v77
    v_mul_f32 v76, 0x3b124925, v76
    v_fma_f32 v76, -v72, v72, v76
    v_max_f32 v76, 0, v76
    v_mov_b32 v82, v76
    v_cvt_pk_bf16_f32 v82, v82, v82
    v_lshlrev_b32 v82, 16, v82
    v_add_f32 v82, 0x3727c5ac, v82
    v_cvt_pk_bf16_f32 v82, v82, v82
    v_lshlrev_b32 v82, 16, v82
    v_sqrt_f32 v82, v82
    s_nop 0
    v_cvt_pk_bf16_f32 v82, v82, v82
    v_lshlrev_b32 v82, 16, v82
    v_rcp_f32 v82, v82
    s_nop 0
    v_mul_f32 v84, v76, v82
    v_mul_f32 v86, v72, v82
    v_mul_f32 v84, v84, v82
    v_cvt_pk_bf16_f32 v86, v86, v86
    v_lshlrev_b32 v86, 16, v86
    v_pk_mul_f32 v[32:33], v[16:17], v[82:83] op_sel_hi:[1,0]
    v_pk_mul_f32 v[34:35], v[18:19], v[82:83] op_sel_hi:[1,0]
    v_pk_mul_f32 v[36:37], v[20:21], v[82:83] op_sel_hi:[1,0]
    v_pk_mul_f32 v[38:39], v[22:23], v[82:83] op_sel_hi:[1,0]
    v_pk_mul_f32 v[40:41], v[24:25], v[82:83] op_sel_hi:[1,0]
    v_pk_mul_f32 v[42:43], v[26:27], v[82:83] op_sel_hi:[1,0]
    v_pk_mul_f32 v[44:45], v[28:29], v[82:83] op_sel_hi:[1,0]
    v_pk_mul_f32 v[46:47], v[30:31], v[82:83] op_sel_hi:[1,0]
    v_cvt_pk_bf16_f32 v84, v84, v84
    v_lshlrev_b32 v84, 16, v84
    v_add_f32 v84, 0x3727c5ac, v84
    v_cvt_pk_bf16_f32 v84, v84, v84
    v_lshlrev_b32 v84, 16, v84
    v_sqrt_f32 v84, v84
    s_nop 0
    v_cvt_pk_bf16_f32 v84, v84, v84
    v_lshlrev_b32 v84, 16, v84
    v_rcp_f32 v84, v84
    v_cvt_pk_bf16_f32 v8, v32, v33
    v_cvt_pk_bf16_f32 v9, v34, v35
    v_cvt_pk_bf16_f32 v10, v36, v37
    v_cvt_pk_bf16_f32 v11, v38, v39
    v_cvt_pk_bf16_f32 v12, v40, v41
    v_cvt_pk_bf16_f32 v13, v42, v43
    v_cvt_pk_bf16_f32 v14, v44, v45
    v_cvt_pk_bf16_f32 v15, v46, v47
    ds_write_b128 v3, v[8:11]
    ds_write_b128 v3, v[12:15] offset:16
    v_mul_f32 v86, v86, v84
    v_pk_fma_f32 v[32:33], v[32:33], v[84:85], v[86:87] op_sel_hi:[1,0,0] neg_lo:[0,0,1] neg_hi:[0,0,1]
    v_pk_fma_f32 v[34:35], v[34:35], v[84:85], v[86:87] op_sel_hi:[1,0,0] neg_lo:[0,0,1] neg_hi:[0,0,1]
    v_pk_fma_f32 v[36:37], v[36:37], v[84:85], v[86:87] op_sel_hi:[1,0,0] neg_lo:[0,0,1] neg_hi:[0,0,1]
    v_pk_fma_f32 v[38:39], v[38:39], v[84:85], v[86:87] op_sel_hi:[1,0,0] neg_lo:[0,0,1] neg_hi:[0,0,1]
    v_pk_fma_f32 v[40:41], v[40:41], v[84:85], v[86:87] op_sel_hi:[1,0,0] neg_lo:[0,0,1] neg_hi:[0,0,1]
    v_pk_fma_f32 v[42:43], v[42:43], v[84:85], v[86:87] op_sel_hi:[1,0,0] neg_lo:[0,0,1] neg_hi:[0,0,1]
    v_pk_fma_f32 v[44:45], v[44:45], v[84:85], v[86:87] op_sel_hi:[1,0,0] neg_lo:[0,0,1] neg_hi:[0,0,1]
    v_pk_fma_f32 v[46:47], v[46:47], v[84:85], v[86:87] op_sel_hi:[1,0,0] neg_lo:[0,0,1] neg_hi:[0,0,1]
    v_cvt_pk_bf16_f32 v16, v32, v33
    v_cvt_pk_bf16_f32 v17, v34, v35
    v_cvt_pk_bf16_f32 v18, v36, v37
    v_cvt_pk_bf16_f32 v19, v38, v39
    v_cvt_pk_bf16_f32 v20, v40, v41
    v_cvt_pk_bf16_f32 v21, v42, v43
    v_cvt_pk_bf16_f32 v22, v44, v45
    v_cvt_pk_bf16_f32 v23, v46, v47
    ds_write_b128 v5, v[16:19] offset:7168
    ds_write_b128 v5, v[20:23] offset:7184
    s_waitcnt lgkmcnt(0)
    s_barrier
    ds_read_b64_tr_b16 v[28:29], v88 offset:7168
    ds_read_b64_tr_b16 v[30:31], v88 offset:10816
    ds_read_b128 v[36:39], v91
    ds_read_b64_tr_b16 v[32:33], v88 offset:7680
    ds_read_b64_tr_b16 v[34:35], v88 offset:11328
    ds_read_b128 v[40:43], v91 offset:512
    s_waitcnt lgkmcnt(4)
    buffer_store_dwordx4 v[28:31], v92, s[32:35], s21 offen sc1
    s_waitcnt lgkmcnt(3)
    buffer_store_dwordx4 v[36:39], v89, s[32:35], s20 offen sc1
    s_waitcnt lgkmcnt(1)
    buffer_store_dwordx4 v[32:35], v92, s[32:35], s22 offen sc1
    s_waitcnt lgkmcnt(0)
    buffer_store_dwordx4 v[40:43], v89, s[32:35], s24 offen sc1
    buffer_load_dword v249, v248, s[44:47], 0 offen sc1
    s_lshl_b32 s36, s38, 2
    s_add_u32 s36, s36, s14
    s_mul_i32 s24, s36, 28672
    s_lshl_b32 s26, s14, 10
    s_add_u32 s25, s25, s26
    v_add_u32 v254, 0x8000, v252
    s_waitcnt vmcnt(0) lgkmcnt(0)
    s_barrier
    v_readfirstlane_b32 s61, v249
    s_cmp_lg_u32 s61, 0
    s_cbranch_scc1 A_RDY
    s_mov_b32 s60, 0
    s_mov_b64 exec, 1
POLL_1:
    buffer_load_dword v249, v248, s[44:47], 0 offen sc1
    s_add_u32 s60, s60, 1
    s_waitcnt vmcnt(0)
    v_readfirstlane_b32 s61, v249
    s_cmp_ge_u32 s61, 1
    s_cbranch_scc1 POLLD_2
    s_sleep 1
    s_cmp_lt_u32 s60, 0x40000
    s_cbranch_scc1 POLL_1
POLLD_2:
    s_mov_b64 exec, -1
A_RDY:
    s_mov_b32 s43, 1
    s_cmp_lg_u32 s14, 0
    s_cbranch_scc1 A_ARR
    s_mov_b32 s62, 1
    s_atomic_add s62, s[30:31], s41 offset:0 glc
    s_waitcnt lgkmcnt(0)
    s_cmp_eq_u32 s62, 15
    s_cselect_b32 s43, 1, 0
    s_cbranch_scc0 A_ARR
    s_mov_b32 s62, 1
    s_atomic_add s62, s[30:31], s41 offset:4096
    s_mov_b32 s20, 0x842400
    s_mov_b32 s63, 1
    s_atomic_add s63, s[30:31], s20 glc
    s_waitcnt lgkmcnt(0)
    s_cmp_lg_u32 s63, 15
    s_cbranch_scc1 A_ARR
    s_atomic_add s62, s[28:29], 0x80
A_ARR:
    s_lshl_b32 s20, s56, 8
    s_add_u32 s20, s20, 0x843000
    s_mov_b32 s60, 0
    s_mov_b64 exec, 1
POLL_3:
    buffer_load_dword v249, v248, s[32:35], s20 offen sc1
    s_add_u32 s60, s60, 1
    s_waitcnt vmcnt(0)
    v_readfirstlane_b32 s61, v249
    s_cmp_ge_u32 s61, 1
    s_cbranch_scc1 POLLD_4
    s_sleep 1
    s_cmp_lt_u32 s60, 0x40000
    s_cbranch_scc1 POLL_3
POLLD_4:
    s_mov_b64 exec, -1
    s_add_u32 m0, s26, 0
    s_add_u32 s28, s25, 0
    buffer_load_dwordx4 v251, s[32:35], s28 offen sc1 lds
    s_add_u32 m0, s26, 4096
    s_add_u32 s28, s25, 4096
    buffer_load_dwordx4 v251, s[32:35], s28 offen sc1 lds
    s_add_u32 m0, s26, 8192
    s_add_u32 s28, s25, 8192
    buffer_load_dwordx4 v251, s[32:35], s28 offen sc1 lds
    s_add_u32 m0, s26, 12288
    s_add_u32 s28, s25, 12288
    buffer_load_dwordx4 v251, s[32:35], s28 offen sc1 lds
    s_add_u32 m0, s26, 16384
    s_add_u32 s28, s25, 16384
    buffer_load_dwordx4 v251, s[32:35], s28 offen sc1 lds
    s_add_u32 m0, s26, 20480
    s_add_u32 s28, s25, 20480
    buffer_load_dwordx4 v251, s[32:35], s28 offen sc1 lds
    s_cmp_lg_u32 s43, 0
    s_cbranch_scc1 A_GO
    s_add_u32 s21, s41, 4096
    s_mov_b32 s60, 0
    s_mov_b64 exec, 1
POLL_5:
    buffer_load_dword v249, v248, s[32:35], s21 offen sc1
    s_add_u32 s60, s60, 1
    s_waitcnt vmcnt(0)
    v_readfirstlane_b32 s61, v249
    s_cmp_ge_u32 s61, 1
    s_cbranch_scc1 POLLD_6
    s_sleep 1
    s_cmp_lt_u32 s60, 0x40000
    s_cbranch_scc1 POLL_5
POLLD_6:
    s_mov_b64 exec, -1
A_GO:
    s_barrier
    s_sub_u32 s27, s25, s26
    s_add_u32 s27, s27, 75264
    s_add_u32 s20, s20, 2048
    buffer_load_dwordx4 v[64:67], v251, s[32:35], s24 offen offset:0 sc1
    buffer_load_dwordx4 v[68:71], v251, s[32:35], s24 offen offset:1024 sc1
    buffer_load_dwordx4 v[72:75], v251, s[32:35], s24 offen offset:2048 sc1
    buffer_load_dwordx4 v[76:79], v251, s[32:35], s24 offen offset:3072 sc1
    s_add_u32 s24, s24, 4096
    buffer_load_dwordx4 v[80:83], v251, s[32:35], s24 offen offset:0 sc1
    buffer_load_dwordx4 v[84:87], v251, s[32:35], s24 offen offset:1024 sc1
    buffer_load_dwordx4 v[88:91], v251, s[32:35], s24 offen offset:2048 sc1
    buffer_load_dwordx4 v[92:95], v251, s[32:35], s24 offen offset:3072 sc1
    s_add_u32 s24, s24, 4096
    buffer_load_dwordx4 v[96:99], v251, s[32:35], s24 offen offset:0 sc1
    buffer_load_dwordx4 v[100:103], v251, s[32:35], s24 offen offset:1024 sc1
    buffer_load_dwordx4 v[104:107], v251, s[32:35], s24 offen offset:2048 sc1
    buffer_load_dwordx4 v[108:111], v251, s[32:35], s24 offen offset:3072 sc1
    s_waitcnt vmcnt(15)
    s_barrier
    ds_read_b128 v[176:179], v252 offset:0
    ds_read_b128 v[180:183], v252 offset:896
    ds_read_b128 v[184:187], v252 offset:1792
    ds_read_b128 v[188:191], v252 offset:2688
    ds_read_b128 v[192:195], v252 offset:3584
    ds_read_b128 v[196:199], v252 offset:4480
    s_waitcnt vmcnt(11) lgkmcnt(4)
    v_mfma_f32_32x32x16_bf16 v[16:31], v[176:179], v[64:67], 0
    s_add_u32 s24, s24, 4096
    buffer_load_dwordx4 v[112:115], v251, s[32:35], s24 offen offset:0 sc1
    v_mfma_f32_32x32x16_bf16 v[32:47], v[64:67], v[180:183], 0
    s_add_u32 m0, s26, 24576
    s_add_u32 s28, s25, 24576
    buffer_load_dwordx4 v251, s[32:35], s28 offen sc1 lds
    ds_read_b128 v[176:179], v252 offset:5376
    ds_read_b128 v[180:183], v252 offset:6272
    s_waitcnt vmcnt(12) lgkmcnt(4)
    v_mfma_f32_32x32x16_bf16 v[16:31], v[184:187], v[68:71], v[16:31]
    s_add_u32 m0, s26, 28672
    s_add_u32 s28, s25, 28672
    buffer_load_dwordx4 v251, s[32:35], s28 offen sc1 lds
    v_mfma_f32_32x32x16_bf16 v[32:47], v[68:71], v[188:191], v[32:47]
    s_add_u32 m0, s26, 32768
    s_add_u32 s28, s25, 32768
    buffer_load_dwordx4 v251, s[32:35], s28 offen sc1 lds
    ds_read_b128 v[184:187], v252 offset:7168
    ds_read_b128 v[188:191], v252 offset:8064
    s_waitcnt vmcnt(13) lgkmcnt(4)
    v_mfma_f32_32x32x16_bf16 v[16:31], v[192:195], v[72:75], v[16:31]
    buffer_load_dwordx4 v[116:119], v251, s[32:35], s24 offen offset:1024 sc1
    v_mfma_f32_32x32x16_bf16 v[32:47], v[72:75], v[196:199], v[32:47]
    buffer_load_dwordx4 v[120:123], v251, s[32:35], s24 offen offset:2048 sc1
    ds_read_b128 v[192:195], v252 offset:8960
    ds_read_b128 v[196:199], v252 offset:9856
    s_waitcnt vmcnt(14) lgkmcnt(4)
    v_mfma_f32_32x32x16_bf16 v[16:31], v[176:179], v[76:79], v[16:31]
    buffer_load_dwordx4 v[124:127], v251, s[32:35], s24 offen offset:3072 sc1
    v_mfma_f32_32x32x16_bf16 v[32:47], v[76:79], v[180:183], v[32:47]
    s_add_u32 s24, s24, 4096
    buffer_load_dwordx4 v[128:131], v251, s[32:35], s24 offen offset:0 sc1
    s_waitcnt vmcnt(15) lgkmcnt(2)
    v_mfma_f32_32x32x16_bf16 v[16:31], v[184:187], v[80:83], v[16:31]
    buffer_load_dwordx4 v[132:135], v251, s[32:35], s24 offen offset:1024 sc1
    v_mfma_f32_32x32x16_bf16 v[32:47], v[80:83], v[188:191], v[32:47]
    buffer_load_dwordx4 v[136:139], v251, s[32:35], s24 offen offset:2048 sc1
    s_waitcnt vmcnt(16) lgkmcnt(0)
    v_mfma_f32_32x32x16_bf16 v[16:31], v[192:195], v[84:87], v[16:31]
    buffer_load_dwordx4 v[140:143], v251, s[32:35], s24 offen offset:3072 sc1
    v_mfma_f32_32x32x16_bf16 v[32:47], v[84:87], v[196:199], v[32:47]
    s_add_u32 m0, s26, 36864
    s_add_u32 s28, s25, 36864
    buffer_load_dwordx4 v251, s[32:35], s28 offen sc1 lds
    s_barrier
    ds_read_b128 v[176:179], v252 offset:10752
    ds_read_b128 v[180:183], v252 offset:11648
    ds_read_b128 v[184:187], v252 offset:12544
    ds_read_b128 v[188:191], v252 offset:13440
    ds_read_b128 v[192:195], v252 offset:14336
    ds_read_b128 v[196:199], v252 offset:15232
    s_waitcnt vmcnt(17) lgkmcnt(4)
    v_mfma_f32_32x32x16_bf16 v[16:31], v[176:179], v[88:91], v[16:31]
    s_add_u32 m0, s26, 40960
    s_add_u32 s28, s25, 40960
    buffer_load_dwordx4 v251, s[32:35], s28 offen sc1 lds
    v_mfma_f32_32x32x16_bf16 v[32:47], v[88:91], v[180:183], v[32:47]
    s_add_u32 m0, s26, 45056
    s_add_u32 s28, s25, 45056
    buffer_load_dwordx4 v251, s[32:35], s28 offen sc1 lds
    ds_read_b128 v[176:179], v252 offset:16128
    ds_read_b128 v[180:183], v252 offset:17024
    s_waitcnt vmcnt(18) lgkmcnt(4)
    v_mfma_f32_32x32x16_bf16 v[16:31], v[184:187], v[92:95], v[16:31]
    s_add_u32 m0, s26, 49152
    s_add_u32 s28, s25, 49152
    buffer_load_dwordx4 v251, s[32:35], s28 offen sc1 lds
    v_mfma_f32_32x32x16_bf16 v[32:47], v[92:95], v[188:191], v[32:47]
    s_add_u32 s24, s24, 4096
    buffer_load_dwordx4 v[144:147], v251, s[32:35], s24 offen offset:0 sc1
    ds_read_b128 v[184:187], v252 offset:17920
    ds_read_b128 v[188:191], v252 offset:18816
    s_waitcnt vmcnt(19) lgkmcnt(4)
    v_mfma_f32_32x32x16_bf16 v[16:31], v[192:195], v[96:99], v[16:31]
    buffer_load_dwordx4 v[148:151], v251, s[32:35], s24 offen offset:1024 sc1
    v_mfma_f32_32x32x16_bf16 v[32:47], v[96:99], v[196:199], v[32:47]
    buffer_load_dwordx4 v[152:155], v251, s[32:35], s24 offen offset:2048 sc1
    ds_read_b128 v[192:195], v252 offset:19712
    ds_read_b128 v[196:199], v252 offset:20608
    s_waitcnt vmcnt(20) lgkmcnt(4)
    v_mfma_f32_32x32x16_bf16 v[16:31], v[176:179], v[100:103], v[16:31]
    buffer_load_dwordx4 v[156:159], v251, s[32:35], s24 offen offset:3072 sc1
    v_mfma_f32_32x32x16_bf16 v[32:47], v[100:103], v[180:183], v[32:47]
    s_add_u32 s24, s24, 4096
    buffer_load_dwordx4 v[160:163], v251, s[32:35], s24 offen offset:0 sc1
    ds_read_b128 v[176:179], v252 offset:21504
    ds_read_b128 v[180:183], v252 offset:22400
    s_waitcnt vmcnt(21) lgkmcnt(4)
    v_mfma_f32_32x32x16_bf16 v[16:31], v[184:187], v[104:107], v[16:31]
    buffer_load_dwordx4 v[164:167], v251, s[32:35], s24 offen offset:1024 sc1
    v_mfma_f32_32x32x16_bf16 v[32:47], v[104:107], v[188:191], v[32:47]
    buffer_load_dwordx4 v[168:171], v251, s[32:35], s24 offen offset:2048 sc1
    s_waitcnt vmcnt(22) lgkmcnt(2)
    v_mfma_f32_32x32x16_bf16 v[16:31], v[192:195], v[108:111], v[16:31]
    buffer_load_dwordx4 v[172:175], v251, s[32:35], s24 offen offset:3072 sc1
    v_mfma_f32_32x32x16_bf16 v[32:47], v[108:111], v[196:199], v[32:47]
    buffer_load_dwordx4 v[208:211], v251, s[32:35], s27 offen offset:0 sc1
    s_waitcnt vmcnt(23) lgkmcnt(0)
    v_mfma_f32_32x32x16_bf16 v[16:31], v[176:179], v[112:115], v[16:31]
    buffer_load_dwordx4 v[212:215], v251, s[32:35], s27 offen offset:1024 sc1
    v_mfma_f32_32x32x16_bf16 v[32:47], v[112:115], v[180:183], v[32:47]
    s_waitcnt vmcnt(21)
    s_barrier
    ds_read_b128 v[184:187], v252 offset:23296
    ds_read_b128 v[188:191], v252 offset:24192
    ds_read_b128 v[192:195], v252 offset:25088
    ds_read_b128 v[196:199], v252 offset:25984
    ds_read_b128 v[176:179], v252 offset:26880
    ds_read_b128 v[180:183], v252 offset:27776
    s_waitcnt vmcnt(20) lgkmcnt(4)
    v_mfma_f32_32x32x16_bf16 v[16:31], v[184:187], v[116:119], v[16:31]
    v_mfma_f32_32x32x16_bf16 v[32:47], v[116:119], v[188:191], v[32:47]
    ds_read_b128 v[184:187], v252 offset:28672
    ds_read_b128 v[188:191], v252 offset:29568
    s_waitcnt vmcnt(19) lgkmcnt(4)
    v_mfma_f32_32x32x16_bf16 v[16:31], v[192:195], v[120:123], v[16:31]
    v_mfma_f32_32x32x16_bf16 v[32:47], v[120:123], v[196:199], v[32:47]
    ds_read_b128 v[192:195], v252 offset:30464
    ds_read_b128 v[196:199], v252 offset:31360
    s_waitcnt vmcnt(18) lgkmcnt(4)
    v_mfma_f32_32x32x16_bf16 v[16:31], v[176:179], v[124:127], v[16:31]
    v_mfma_f32_32x32x16_bf16 v[32:47], v[124:127], v[180:183], v[32:47]
    ds_read_b128 v[176:179], v252 offset:32256
    ds_read_b128 v[180:183], v252 offset:33152
    s_waitcnt vmcnt(17) lgkmcnt(4)
    v_mfma_f32_32x32x16_bf16 v[16:31], v[184:187], v[128:131], v[16:31]
    v_mfma_f32_32x32x16_bf16 v[32:47], v[128:131], v[188:191], v[32:47]
    ds_read_b128 v[184:187], v252 offset:34048
    ds_read_b128 v[188:191], v252 offset:34944
    s_waitcnt vmcnt(16) lgkmcnt(4)
    v_mfma_f32_32x32x16_bf16 v[16:31], v[192:195], v[132:135], v[16:31]
    v_mfma_f32_32x32x16_bf16 v[32:47], v[132:135], v[196:199], v[32:47]
    s_waitcnt vmcnt(15) lgkmcnt(2)
    v_mfma_f32_32x32x16_bf16 v[16:31], v[176:179], v[136:139], v[16:31]
    v_mfma_f32_32x32x16_bf16 v[32:47], v[136:139], v[180:183], v[32:47]
    s_waitcnt vmcnt(14) lgkmcnt(0)
    v_mfma_f32_32x32x16_bf16 v[16:31], v[184:187], v[140:143], v[16:31]
    v_mfma_f32_32x32x16_bf16 v[32:47], v[140:143], v[188:191], v[32:47]
    s_waitcnt vmcnt(10)
    s_barrier
    ds_read_b128 v[192:195], v252 offset:35840
    ds_read_b128 v[196:199], v252 offset:36736
    ds_read_b128 v[176:179], v252 offset:37632
    ds_read_b128 v[180:183], v252 offset:38528
    ds_read_b128 v[184:187], v252 offset:39424
    ds_read_b128 v[188:191], v252 offset:40320
    s_waitcnt vmcnt(9) lgkmcnt(4)
    v_mfma_f32_32x32x16_bf16 v[16:31], v[192:195], v[144:147], v[16:31]
    v_mfma_f32_32x32x16_bf16 v[32:47], v[144:147], v[196:199], v[32:47]
    ds_read_b128 v[192:195], v252 offset:41216
    ds_read_b128 v[196:199], v252 offset:42112
    s_waitcnt vmcnt(8) lgkmcnt(4)
    v_mfma_f32_32x32x16_bf16 v[16:31], v[176:179], v[148:151], v[16:31]
    v_mfma_f32_32x32x16_bf16 v[32:47], v[148:151], v[180:183], v[32:47]
    ds_read_b128 v[176:179], v252 offset:43008
    ds_read_b128 v[180:183], v252 offset:43904
    s_waitcnt vmcnt(7) lgkmcnt(4)
    v_mfma_f32_32x32x16_bf16 v[16:31], v[184:187], v[152:155], v[16:31]
    v_mfma_f32_32x32x16_bf16 v[32:47], v[152:155], v[188:191], v[32:47]
    ds_read_b128 v[184:187], v252 offset:44800
    ds_read_b128 v[188:191], v252 offset:45696
    s_waitcnt vmcnt(6) lgkmcnt(4)
    v_mfma_f32_32x32x16_bf16 v[16:31], v[192:195], v[156:159], v[16:31]
    v_mfma_f32_32x32x16_bf16 v[32:47], v[156:159], v[196:199], v[32:47]
    ds_read_b128 v[192:195], v252 offset:46592
    ds_read_b128 v[196:199], v252 offset:47488
    s_waitcnt vmcnt(5) lgkmcnt(4)
    v_mfma_f32_32x32x16_bf16 v[16:31], v[176:179], v[160:163], v[16:31]
    v_mfma_f32_32x32x16_bf16 v[32:47], v[160:163], v[180:183], v[32:47]
    ds_read_b128 v[176:179], v252 offset:48384
    ds_read_b128 v[180:183], v252 offset:49280
    s_waitcnt vmcnt(4) lgkmcnt(4)
    v_mfma_f32_32x32x16_bf16 v[16:31], v[184:187], v[164:167], v[16:31]
    v_mfma_f32_32x32x16_bf16 v[32:47], v[164:167], v[188:191], v[32:47]
    s_waitcnt vmcnt(3) lgkmcnt(2)
    v_mfma_f32_32x32x16_bf16 v[16:31], v[192:195], v[168:171], v[16:31]
    v_mfma_f32_32x32x16_bf16 v[32:47], v[168:171], v[196:199], v[32:47]
    s_waitcnt vmcnt(2) lgkmcnt(0)
    v_mfma_f32_32x32x16_bf16 v[16:31], v[176:179], v[172:175], v[16:31]
    v_mfma_f32_32x32x16_bf16 v[32:47], v[172:175], v[180:183], v[32:47]
    s_waitcnt vmcnt(0)
    buffer_load_dword v249, v248, s[32:35], s20 offen sc1
    s_barrier
    s_mov_b32 s56, 0
    s_mov_b32 s57, -1
    s_mov_b32 s37, 0x3fb8aa3b
    v_mul_u32_u24 v204, 136, v253
    v_lshl_add_u32 v204, v255, 3, v204
    s_mul_i32 s28, s14, 4352
    v_add_u32 v204, s28, v204
    s_lshl_b32 s28, s14, 11
    v_add_u32 v205, s28, v251
    v_cmp_eq_u32 vcc, 28, v253
    v_mov_b32 v192, 0x3f803f80
    v_cvt_pk_bf16_f32 v48, v16, v17
    v_cvt_pk_bf16_f32 v49, v18, v19
    v_cvt_pk_bf16_f32 v50, v20, v21
    v_cvt_pk_bf16_f32 v51, v22, v23
    v_cvt_pk_bf16_f32 v52, v24, v25
    v_cvt_pk_bf16_f32 v53, v26, v27
    v_cvt_pk_bf16_f32 v54, v28, v29
    v_cvt_pk_bf16_f32 v55, v30, v31
    v_cndmask_b32 v192, 0, v192, vcc
    v_mfma_f32_32x32x16_bf16 v[216:231], v[208:211], v[48:51], 0
    v_mfma_f32_32x32x16_bf16 v[216:231], v[212:215], v[52:55], v[216:231]
    v_cvt_pk_bf16_f32 v56, v32, v33
    v_cvt_pk_bf16_f32 v57, v34, v35
    v_cvt_pk_bf16_f32 v58, v36, v37
    v_cvt_pk_bf16_f32 v59, v38, v39
    v_cvt_pk_bf16_f32 v60, v40, v41
    v_cvt_pk_bf16_f32 v61, v42, v43
    v_cvt_pk_bf16_f32 v62, v44, v45
    v_cvt_pk_bf16_f32 v63, v46, v47
    v_cndmask_b32 v56, v192, v56, s[58:59]
    v_cndmask_b32 v57, v192, v57, s[58:59]
    v_cndmask_b32 v58, v192, v58, s[58:59]
    v_cndmask_b32 v59, v192, v59, s[58:59]
    v_cndmask_b32 v60, v192, v60, s[58:59]
    v_cndmask_b32 v61, v192, v61, s[58:59]
    v_cndmask_b32 v62, v192, v62, s[58:59]
    v_cndmask_b32 v63, v192, v63, s[58:59]
    ds_write_b128 v205, v[56:59] offset:17408
    ds_write_b128 v205, v[60:63] offset:18432
    v_max3_f32 v194, v228, v229, v230
    v_max3_f32 v192, v216, v217, v218
    v_max_f32 v194, v194, v231
    v_max3_f32 v192, v192, v219, v220
    v_max3_f32 v192, v192, v221, v222
    v_max3_f32 v192, v192, v223, v224
    v_max3_f32 v192, v192, v225, v226
    v_cndmask_b32 v194, v194, v216, s[56:57]
    v_max3_f32 v192, v192, v227, v194
    v_min3_f32 v195, v228, v229, v230
    v_min3_f32 v193, v216, v217, v218
    v_min_f32 v195, v195, v231
    v_min3_f32 v193, v193, v219, v220
    v_min3_f32 v193, v193, v221, v222
    v_min3_f32 v193, v193, v223, v224
    v_min3_f32 v193, v193, v225, v226
    v_cndmask_b32 v195, v195, v216, s[56:57]
    v_min3_f32 v193, v193, v227, v195
    v_mov_b32 v194, v192
    v_mov_b32 v195, v193
    v_mov_b32 v196, 0x7f800000
    v_mov_b32 v197, 0xff800000
    v_permlane32_swap_b32 v192, v194
    v_permlane32_swap_b32 v193, v195
    s_nop 0
    v_max_f32 v192, v192, v194
    v_min_f32 v193, v193, v195
    v_mul_f32 v192, s37, v192
    v_mul_f32 v193, s37, v193
    v_cndmask_b32 v196, v192, v196, s[56:57]
    v_cndmask_b32 v197, v193, v197, s[56:57]
    s_waitcnt vmcnt(0)
    v_readfirstlane_b32 s61, v249
    s_cmp_lg_u32 s61, 0
    s_cbranch_scc1 FLAG_7
    s_mov_b32 s60, 0
    s_mov_b64 exec, 1
POLL_8:
    buffer_load_dword v249, v248, s[32:35], s20 offen sc1
    s_add_u32 s60, s60, 1
    s_waitcnt vmcnt(0)
    v_readfirstlane_b32 s61, v249
    s_cmp_ge_u32 s61, 1
    s_cbranch_scc1 POLLD_9
    s_sleep 1
    s_cmp_lt_u32 s60, 0x40000
    s_cbranch_scc1 POLL_8
POLLD_9:
    s_mov_b64 exec, -1
FLAG_7:
    s_add_u32 m0, s26, 49152
    s_add_u32 s28, s25, 49152
    buffer_load_dwordx4 v251, s[32:35], s28 offen sc1 lds
    s_add_u32 m0, s26, 53248
    s_add_u32 s28, s25, 53248
    buffer_load_dwordx4 v251, s[32:35], s28 offen sc1 lds
    s_add_u32 m0, s26, 57344
    s_add_u32 s28, s25, 57344
    buffer_load_dwordx4 v251, s[32:35], s28 offen sc1 lds
    s_add_u32 m0, s26, 61440
    s_add_u32 s28, s25, 61440
    buffer_load_dwordx4 v251, s[32:35], s28 offen sc1 lds
    s_add_u32 m0, s26, 65536
    s_add_u32 s28, s25, 65536
    buffer_load_dwordx4 v251, s[32:35], s28 offen sc1 lds
    s_add_u32 m0, s26, 69632
    s_add_u32 s28, s25, 69632
    buffer_load_dwordx4 v251, s[32:35], s28 offen sc1 lds
    s_add_u32 m0, s26, 73728
    s_add_u32 s28, s25, 73728
    buffer_load_dwordx4 v251, s[32:35], s28 offen sc1 lds
    v_fma_f32 v16, v216, s37, -v192
    v_fma_f32 v32, -v216, s37, v193
    v_fma_f32 v17, v217, s37, -v192
    v_fma_f32 v33, -v217, s37, v193
    v_fma_f32 v18, v218, s37, -v192
    v_fma_f32 v34, -v218, s37, v193
    v_fma_f32 v19, v219, s37, -v192
    v_fma_f32 v35, -v219, s37, v193
    v_fma_f32 v20, v220, s37, -v192
    v_fma_f32 v36, -v220, s37, v193
    v_fma_f32 v21, v221, s37, -v192
    v_fma_f32 v37, -v221, s37, v193
    v_fma_f32 v22, v222, s37, -v192
    v_fma_f32 v38, -v222, s37, v193
    v_fma_f32 v23, v223, s37, -v192
    v_fma_f32 v39, -v223, s37, v193
    v_fma_f32 v24, v224, s37, -v192
    v_fma_f32 v40, -v224, s37, v193
    v_fma_f32 v25, v225, s37, -v192
    v_fma_f32 v41, -v225, s37, v193
    v_fma_f32 v26, v226, s37, -v192
    v_fma_f32 v42, -v226, s37, v193
    v_fma_f32 v27, v227, s37, -v192
    v_fma_f32 v43, -v227, s37, v193
    v_fma_f32 v28, v228, s37, -v196
    v_fma_f32 v44, -v228, s37, v197
    v_fma_f32 v29, v229, s37, -v196
    v_fma_f32 v45, -v229, s37, v197
    v_fma_f32 v30, v230, s37, -v196
    v_fma_f32 v46, -v230, s37, v197
    v_fma_f32 v31, v231, s37, -v196
    v_fma_f32 v47, -v231, s37, v197
    v_exp_f32 v16, v16
    v_exp_f32 v32, v32
    v_exp_f32 v17, v17
    v_exp_f32 v33, v33
    v_exp_f32 v18, v18
    v_exp_f32 v34, v34
    v_add_f32 v192, v16, v17
    v_add_f32 v193, v32, v33
    v_exp_f32 v19, v19
    v_exp_f32 v35, v35
    v_add_f32 v192, v192, v18
    v_add_f32 v193, v193, v34
    v_exp_f32 v20, v20
    v_exp_f32 v36, v36
    v_add_f32 v192, v192, v19
    v_add_f32 v193, v193, v35
    v_exp_f32 v21, v21
    v_exp_f32 v37, v37
    v_add_f32 v192, v192, v20
    v_add_f32 v193, v193, v36
    v_exp_f32 v22, v22
    v_exp_f32 v38, v38
    v_add_f32 v192, v192, v21
    v_add_f32 v193, v193, v37
    v_exp_f32 v23, v23
    v_exp_f32 v39, v39
    v_add_f32 v192, v192, v22
    v_add_f32 v193, v193, v38
    v_exp_f32 v24, v24
    v_exp_f32 v40, v40
    v_add_f32 v192, v192, v23
    v_add_f32 v193, v193, v39
    v_exp_f32 v25, v25
    v_exp_f32 v41, v41
    v_add_f32 v192, v192, v24
    v_add_f32 v193, v193, v40
    v_exp_f32 v26, v26
    v_exp_f32 v42, v42
    v_add_f32 v192, v192, v25
    v_add_f32 v193, v193, v41
    v_exp_f32 v27, v27
    v_exp_f32 v43, v43
    v_add_f32 v192, v192, v26
    v_add_f32 v193, v193, v42
    v_exp_f32 v28, v28
    v_exp_f32 v44, v44
    v_add_f32 v192, v192, v27
    v_add_f32 v193, v193, v43
    v_exp_f32 v29, v29
    v_exp_f32 v45, v45
    v_add_f32 v192, v192, v28
    v_add_f32 v193, v193, v44
    v_exp_f32 v30, v30
    v_exp_f32 v46, v46
    v_add_f32 v192, v192, v29
    v_add_f32 v193, v193, v45
    v_exp_f32 v31, v31
    v_exp_f32 v47, v47
    v_add_f32 v192, v192, v30
    v_add_f32 v193, v193, v46
    v_add_f32 v192, v192, v31
    v_add_f32 v193, v193, v47
    v_mov_b32 v194, v192
    v_mov_b32 v195, v193
    s_nop 1
    v_permlane32_swap_b32 v192, v194
    v_permlane32_swap_b32 v193, v195
    s_nop 0
    v_add_f32 v192, v192, v194
    v_add_f32 v193, v193, v195
    v_rcp_f32 v192, v192
    v_rcp_f32 v193, v193
    v_mul_f32 v16, v16, v192
    v_mul_f32 v17, v17, v192
    v_mul_f32 v18, v18, v192
    v_mul_f32 v19, v19, v192
    v_cvt_pk_bf16_f32 v176, v16, v17
    v_cvt_pk_bf16_f32 v177, v18, v19
    ds_write_b64 v204, v[176:177] offset:0
    v_mul_f32 v20, v20, v192
    v_mul_f32 v21, v21, v192
    v_mul_f32 v22, v22, v192
    v_mul_f32 v23, v23, v192
    v_cvt_pk_bf16_f32 v178, v20, v21
    v_cvt_pk_bf16_f32 v179, v22, v23
    ds_write_b64 v204, v[178:179] offset:16
    v_mul_f32 v24, v24, v192
    v_mul_f32 v25, v25, v192
    v_mul_f32 v26, v26, v192
    v_mul_f32 v27, v27, v192
    v_cvt_pk_bf16_f32 v180, v24, v25
    v_cvt_pk_bf16_f32 v181, v26, v27
    ds_write_b64 v204, v[180:181] offset:32
    v_mul_f32 v28, v28, v192
    v_mul_f32 v29, v29, v192
    v_mul_f32 v30, v30, v192
    v_mul_f32 v31, v31, v192
    v_cvt_pk_bf16_f32 v182, v28, v29
    v_cvt_pk_bf16_f32 v183, v30, v31
    ds_write_b64 v204, v[182:183] offset:48
    v_mul_f32 v32, v32, v193
    v_mul_f32 v33, v33, v193
    v_mul_f32 v34, v34, v193
    v_mul_f32 v35, v35, v193
    v_cvt_pk_bf16_f32 v184, v32, v33
    v_cvt_pk_bf16_f32 v185, v34, v35
    ds_write_b64 v204, v[184:185] offset:64
    v_mul_f32 v36, v36, v193
    v_mul_f32 v37, v37, v193
    v_mul_f32 v38, v38, v193
    v_mul_f32 v39, v39, v193
    v_cvt_pk_bf16_f32 v186, v36, v37
    v_cvt_pk_bf16_f32 v187, v38, v39
    ds_write_b64 v204, v[186:187] offset:80
    v_mul_f32 v40, v40, v193
    v_mul_f32 v41, v41, v193
    v_mul_f32 v42, v42, v193
    v_mul_f32 v43, v43, v193
    v_cvt_pk_bf16_f32 v188, v40, v41
    v_cvt_pk_bf16_f32 v189, v42, v43
    ds_write_b64 v204, v[188:189] offset:96
    v_mul_f32 v44, v44, v193
    v_mul_f32 v45, v45, v193
    v_mul_f32 v46, v46, v193
    v_mul_f32 v47, v47, v193
    v_cvt_pk_bf16_f32 v190, v44, v45
    v_cvt_pk_bf16_f32 v191, v46, v47
    ds_write_b64 v204, v[190:191] offset:112
    v_lshlrev_b32 v206, 2, v255
    v_bfe_u32 v207, v250, 2, 2
    v_add_u32 v206, v206, v207
    v_mul_u32_u24 v206, 136, v206
    v_bfe_u32 v207, v250, 4, 1
    v_lshl_add_u32 v206, v207, 5, v206
    v_and_b32 v207, 3, v250
    v_lshl_add_u32 v206, v207, 3, v206
    s_lshl_b32 s28, s14, 6
    v_add_u32 v206, s28, v206
    s_lshl_b32 s42, s39, 16
    s_add_u32 s42, s42, 0xb00000
    s_lshl_b32 s28, s38, 10
    s_lshl_b32 s29, s14, 15
    s_add_u32 s28, s28, s29
    s_add_u32 s28, s28, s42
    s_add_u32 s29, s28, 16384
    s_waitcnt vmcnt(0) lgkmcnt(0)
    s_barrier
    s_cmp_ge_u32 s14, 2
    s_cbranch_scc1 A_QPASS
    ds_read_b64_tr_b16 v[0:1], v206 offset:0
    ds_read_b64_tr_b16 v[2:3], v206 offset:1088
    ds_read_b128 v[32:35], v251 offset:17408
    ds_read_b64_tr_b16 v[4:5], v206 offset:2176
    ds_read_b64_tr_b16 v[6:7], v206 offset:3264
    ds_read_b128 v[36:39], v251 offset:18432
    ds_read_b64_tr_b16 v[8:9], v206 offset:4352
    ds_read_b64_tr_b16 v[10:11], v206 offset:5440
    ds_read_b128 v[40:43], v251 offset:19456
    ds_read_b64_tr_b16 v[12:13], v206 offset:6528
    ds_read_b64_tr_b16 v[14:15], v206 offset:7616
    ds_read_b128 v[44:47], v251 offset:20480
    ds_read_b64_tr_b16 v[16:17], v206 offset:8704
    ds_read_b64_tr_b16 v[18:19], v206 offset:9792
    ds_read_b128 v[48:51], v251 offset:21504
    ds_read_b64_tr_b16 v[20:21], v206 offset:10880
    ds_read_b64_tr_b16 v[22:23], v206 offset:11968
    ds_read_b128 v[52:55], v251 offset:22528
    ds_read_b64_tr_b16 v[24:25], v206 offset:13056
    ds_read_b64_tr_b16 v[26:27], v206 offset:14144
    ds_read_b128 v[56:59], v251 offset:23552
    ds_read_b64_tr_b16 v[28:29], v206 offset:15232
    ds_read_b64_tr_b16 v[30:31], v206 offset:16320
    ds_read_b128 v[60:63], v251 offset:24576
    s_waitcnt lgkmcnt(15)
    v_mfma_f32_32x32x16_bf16 v[232:247], v[0:3], v[32:35], 0
    v_mfma_f32_32x32x16_bf16 v[232:247], v[4:7], v[36:39], v[232:247]
    v_mfma_f32_32x32x16_bf16 v[232:247], v[8:11], v[40:43], v[232:247]
    s_waitcnt lgkmcnt(12)
    v_mfma_f32_32x32x16_bf16 v[232:247], v[12:15], v[44:47], v[232:247]
    s_waitcnt lgkmcnt(9)
    v_mfma_f32_32x32x16_bf16 v[232:247], v[16:19], v[48:51], v[232:247]
    s_waitcnt lgkmcnt(6)
    v_mfma_f32_32x32x16_bf16 v[232:247], v[20:23], v[52:55], v[232:247]
    s_waitcnt lgkmcnt(3)
    v_mfma_f32_32x32x16_bf16 v[232:247], v[24:27], v[56:59], v[232:247]
    s_waitcnt lgkmcnt(0)
    v_mfma_f32_32x32x16_bf16 v[232:247], v[28:31], v[60:63], v[232:247]
    s_nop 11
    v_cvt_pk_bf16_f32 v56, v232, v233
    v_cvt_pk_bf16_f32 v57, v234, v235
    v_cvt_pk_bf16_f32 v58, v236, v237
    v_cvt_pk_bf16_f32 v59, v238, v239
    buffer_store_dwordx4 v[56:59], v251, s[32:35], s28 offen sc1
    v_cvt_pk_bf16_f32 v60, v240, v241
    v_cvt_pk_bf16_f32 v61, v242, v243
    v_cvt_pk_bf16_f32 v62, v244, v245
    v_cvt_pk_bf16_f32 v63, v246, v247
    buffer_store_dwordx4 v[60:63], v251, s[32:35], s29 offen sc1
A_QPASS:
    s_setprio 0
    s_mov_b32 s62, 0
    ds_read_b128 v[16:19], v252 offset:50176
    ds_read_b128 v[20:23], v252 offset:51072
    ds_read_b128 v[24:27], v252 offset:51968
    ds_read_b128 v[28:31], v252 offset:52864
    ds_read_b128 v[32:35], v252 offset:53760
    s_waitcnt lgkmcnt(4)
    v_mfma_f32_32x32x16_bf16 v[0:15], v[16:19], v[64:67], 0
    ds_read_b128 v[36:39], v252 offset:54656
    s_waitcnt lgkmcnt(4)
    v_mfma_f32_32x32x16_bf16 v[0:15], v[20:23], v[68:71], v[0:15]
    ds_read_b128 v[40:43], v252 offset:55552
    s_waitcnt lgkmcnt(4)
    v_mfma_f32_32x32x16_bf16 v[0:15], v[24:27], v[72:75], v[0:15]
    ds_read_b128 v[44:47], v252 offset:56448
    s_waitcnt lgkmcnt(4)
    v_mfma_f32_32x32x16_bf16 v[0:15], v[28:31], v[76:79], v[0:15]
    ds_read_b128 v[16:19], v252 offset:57344
    s_waitcnt lgkmcnt(4)
    v_mfma_f32_32x32x16_bf16 v[0:15], v[32:35], v[80:83], v[0:15]
    ds_read_b128 v[20:23], v252 offset:58240
    s_waitcnt lgkmcnt(4)
    v_mfma_f32_32x32x16_bf16 v[0:15], v[36:39], v[84:87], v[0:15]
    ds_read_b128 v[24:27], v252 offset:59136
    s_waitcnt lgkmcnt(4)
    v_mfma_f32_32x32x16_bf16 v[0:15], v[40:43], v[88:91], v[0:15]
    ds_read_b128 v[28:31], v252 offset:60032
    s_waitcnt lgkmcnt(4)
    v_mfma_f32_32x32x16_bf16 v[0:15], v[44:47], v[92:95], v[0:15]
    ds_read_b128 v[32:35], v252 offset:60928
    s_waitcnt lgkmcnt(4)
    v_mfma_f32_32x32x16_bf16 v[0:15], v[16:19], v[96:99], v[0:15]
    ds_read_b128 v[36:39], v252 offset:61824
    s_waitcnt lgkmcnt(4)
    v_mfma_f32_32x32x16_bf16 v[0:15], v[20:23], v[100:103], v[0:15]
    ds_read_b128 v[40:43], v252 offset:62720
    s_waitcnt lgkmcnt(4)
    v_mfma_f32_32x32x16_bf16 v[0:15], v[24:27], v[104:107], v[0:15]
    ds_read_b128 v[44:47], v252 offset:63616
    s_waitcnt lgkmcnt(4)
    v_mfma_f32_32x32x16_bf16 v[0:15], v[28:31], v[108:111], v[0:15]
    ds_read_b128 v[16:19], v252 offset:64512
    s_waitcnt lgkmcnt(4)
    v_mfma_f32_32x32x16_bf16 v[0:15], v[32:35], v[112:115], v[0:15]
    ds_read_b128 v[20:23], v252 offset:65408
    s_waitcnt lgkmcnt(4)
    v_mfma_f32_32x32x16_bf16 v[0:15], v[36:39], v[116:119], v[0:15]
    s_cmp_ge_u32 s14, 2
    s_cbranch_scc1 A_NOARR
    s_waitcnt vmcnt(0)
    s_mov_b32 s62, 1
    s_atomic_add s62, s[30:31], s40 offset:16384 glc
A_NOARR:
    ds_read_b128 v[24:27], v254 offset:33536
    s_waitcnt lgkmcnt(4)
    v_mfma_f32_32x32x16_bf16 v[0:15], v[40:43], v[120:123], v[0:15]
    ds_read_b128 v[28:31], v254 offset:34432
    s_waitcnt lgkmcnt(4)
    v_mfma_f32_32x32x16_bf16 v[0:15], v[44:47], v[124:127], v[0:15]
    ds_read_b128 v[32:35], v254 offset:35328
    s_waitcnt lgkmcnt(4)
    v_mfma_f32_32x32x16_bf16 v[0:15], v[16:19], v[128:131], v[0:15]
    ds_read_b128 v[36:39], v254 offset:36224
    s_waitcnt lgkmcnt(4)
    v_mfma_f32_32x32x16_bf16 v[0:15], v[20:23], v[132:135], v[0:15]
    ds_read_b128 v[40:43], v254 offset:37120
    s_waitcnt lgkmcnt(4)
    v_mfma_f32_32x32x16_bf16 v[0:15], v[24:27], v[136:139], v[0:15]
    ds_read_b128 v[44:47], v254 offset:38016
    s_waitcnt lgkmcnt(4)
    v_mfma_f32_32x32x16_bf16 v[0:15], v[28:31], v[140:143], v[0:15]
    ds_read_b128 v[16:19], v254 offset:38912
    s_waitcnt lgkmcnt(4)
    v_mfma_f32_32x32x16_bf16 v[0:15], v[32:35], v[144:147], v[0:15]
    ds_read_b128 v[20:23], v254 offset:39808
    s_waitcnt lgkmcnt(4)
    v_mfma_f32_32x32x16_bf16 v[0:15], v[36:39], v[148:151], v[0:15]
    ds_read_b128 v[24:27], v254 offset:40704
    s_waitcnt lgkmcnt(4)
    v_mfma_f32_32x32x16_bf16 v[0:15], v[40:43], v[152:155], v[0:15]
    ds_read_b128 v[28:31], v254 offset:41600
    s_waitcnt lgkmcnt(4)
    v_mfma_f32_32x32x16_bf16 v[0:15], v[44:47], v[156:159], v[0:15]
    s_waitcnt lgkmcnt(3)
    v_mfma_f32_32x32x16_bf16 v[0:15], v[16:19], v[160:163], v[0:15]
    s_waitcnt lgkmcnt(2)
    v_mfma_f32_32x32x16_bf16 v[0:15], v[20:23], v[164:167], v[0:15]
    s_waitcnt lgkmcnt(1)
    v_mfma_f32_32x32x16_bf16 v[0:15], v[24:27], v[168:171], v[0:15]
    s_waitcnt lgkmcnt(0)
    v_mfma_f32_32x32x16_bf16 v[0:15], v[28:31], v[172:175], v[0:15]
    s_waitcnt lgkmcnt(0)
    s_cmp_lg_u32 s62, 31
    s_cbranch_scc1 A_S1_NR
    s_mov_b32 s62, 1
    s_atomic_add s62, s[30:31], s40 offset:20480
A_S1_NR:
    s_nop 9
    v_cvt_pk_bf16_f32 v48, v0, v1
    v_cvt_pk_bf16_f32 v49, v2, v3
    v_cvt_pk_bf16_f32 v50, v4, v5
    v_cvt_pk_bf16_f32 v51, v6, v7
    v_cvt_pk_bf16_f32 v52, v8, v9
    v_cvt_pk_bf16_f32 v53, v10, v11
    v_cvt_pk_bf16_f32 v54, v12, v13
    v_cvt_pk_bf16_f32 v55, v14, v15
    s_nop 1
    v_mfma_f32_32x32x16_bf16 v[216:231], v[208:211], v[48:51], 0
    v_mfma_f32_32x32x16_bf16 v[216:231], v[212:215], v[52:55], v[216:231]
    s_nop 11
    v_max3_f32 v194, v228, v229, v230
    v_max3_f32 v192, v216, v217, v218
    v_max_f32 v194, v194, v231
    v_max3_f32 v192, v192, v219, v220
    v_max3_f32 v192, v192, v221, v222
    v_max3_f32 v192, v192, v223, v224
    v_max3_f32 v192, v192, v225, v226
    v_cndmask_b32 v194, v194, v216, s[56:57]
    v_max3_f32 v192, v192, v227, v194
    v_min3_f32 v195, v228, v229, v230
    v_min3_f32 v193, v216, v217, v218
    v_min_f32 v195, v195, v231
    v_min3_f32 v193, v193, v219, v220
    v_min3_f32 v193, v193, v221, v222
    v_min3_f32 v193, v193, v223, v224
    v_min3_f32 v193, v193, v225, v226
    v_cndmask_b32 v195, v195, v216, s[56:57]
    v_min3_f32 v193, v193, v227, v195
    v_mov_b32 v194, v192
    v_mov_b32 v195, v193
    v_mov_b32 v196, 0x7f800000
    v_mov_b32 v197, 0xff800000
    v_permlane32_swap_b32 v192, v194
    v_permlane32_swap_b32 v193, v195
    s_nop 0
    v_max_f32 v192, v192, v194
    v_min_f32 v193, v193, v195
    v_mul_f32 v192, s37, v192
    v_mul_f32 v193, s37, v193
    v_cndmask_b32 v196, v192, v196, s[56:57]
    v_cndmask_b32 v197, v193, v197, s[56:57]
    v_fma_f32 v16, v216, s37, -v192
    v_fma_f32 v32, -v216, s37, v193
    v_fma_f32 v17, v217, s37, -v192
    v_fma_f32 v33, -v217, s37, v193
    v_fma_f32 v18, v218, s37, -v192
    v_fma_f32 v34, -v218, s37, v193
    v_fma_f32 v19, v219, s37, -v192
    v_fma_f32 v35, -v219, s37, v193
    v_fma_f32 v20, v220, s37, -v192
    v_fma_f32 v36, -v220, s37, v193
    v_fma_f32 v21, v221, s37, -v192
    v_fma_f32 v37, -v221, s37, v193
    v_fma_f32 v22, v222, s37, -v192
    v_fma_f32 v38, -v222, s37, v193
    v_fma_f32 v23, v223, s37, -v192
    v_fma_f32 v39, -v223, s37, v193
    v_fma_f32 v24, v224, s37, -v192
    v_fma_f32 v40, -v224, s37, v193
    v_fma_f32 v25, v225, s37, -v192
    v_fma_f32 v41, -v225, s37, v193
    v_fma_f32 v26, v226, s37, -v192
    v_fma_f32 v42, -v226, s37, v193
    v_fma_f32 v27, v227, s37, -v192
    v_fma_f32 v43, -v227, s37, v193
    v_fma_f32 v28, v228, s37, -v196
    v_fma_f32 v44, -v228, s37, v197
    v_fma_f32 v29, v229, s37, -v196
    v_fma_f32 v45, -v229, s37, v197
    v_fma_f32 v30, v230, s37, -v196
    v_fma_f32 v46, -v230, s37, v197
    v_fma_f32 v31, v231, s37, -v196
    v_fma_f32 v47, -v231, s37, v197
    v_exp_f32 v16, v16
    v_exp_f32 v32, v32
    v_exp_f32 v17, v17
    v_exp_f32 v33, v33
    v_exp_f32 v18, v18
    v_exp_f32 v34, v34
    v_add_f32 v192, v16, v17
    v_add_f32 v193, v32, v33
    v_exp_f32 v19, v19
    v_exp_f32 v35, v35
    v_add_f32 v192, v192, v18
    v_add_f32 v193, v193, v34
    v_exp_f32 v20, v20
    v_exp_f32 v36, v36
    v_add_f32 v192, v192, v19
    v_add_f32 v193, v193, v35
    v_exp_f32 v21, v21
    v_exp_f32 v37, v37
    v_add_f32 v192, v192, v20
    v_add_f32 v193, v193, v36
    v_exp_f32 v22, v22
    v_exp_f32 v38, v38
    v_add_f32 v192, v192, v21
    v_add_f32 v193, v193, v37
    v_exp_f32 v23, v23
    v_exp_f32 v39, v39
    v_add_f32 v192, v192, v22
    v_add_f32 v193, v193, v38
    v_exp_f32 v24, v24
    v_exp_f32 v40, v40
    v_add_f32 v192, v192, v23
    v_add_f32 v193, v193, v39
    v_exp_f32 v25, v25
    v_exp_f32 v41, v41
    v_add_f32 v192, v192, v24
    v_add_f32 v193, v193, v40
    v_exp_f32 v26, v26
    v_exp_f32 v42, v42
    v_add_f32 v192, v192, v25
    v_add_f32 v193, v193, v41
    v_exp_f32 v27, v27
    v_exp_f32 v43, v43
    v_add_f32 v192, v192, v26
    v_add_f32 v193, v193, v42
    v_exp_f32 v28, v28
    v_exp_f32 v44, v44
    v_add_f32 v192, v192, v27
    v_add_f32 v193, v193, v43
    v_exp_f32 v29, v29
    v_exp_f32 v45, v45
    v_add_f32 v192, v192, v28
    v_add_f32 v193, v193, v44
    v_exp_f32 v30, v30
    v_exp_f32 v46, v46
    v_add_f32 v192, v192, v29
    v_add_f32 v193, v193, v45
    v_exp_f32 v31, v31
    v_exp_f32 v47, v47
    v_add_f32 v192, v192, v30
    v_add_f32 v193, v193, v46
    v_add_f32 v192, v192, v31
    v_add_f32 v193, v193, v47
    v_mov_b32 v194, v192
    v_mov_b32 v195, v193
    s_nop 1
    v_permlane32_swap_b32 v192, v194
    v_permlane32_swap_b32 v193, v195
    s_nop 0
    v_add_f32 v192, v192, v194
    v_add_f32 v193, v193, v195
    v_rcp_f32 v192, v192
    v_rcp_f32 v193, v193
    v_mul_f32 v16, v16, v192
    v_mul_f32 v17, v17, v192
    v_mul_f32 v18, v18, v192
    v_mul_f32 v19, v19, v192
    v_cvt_pk_bf16_f32 v176, v16, v17
    v_cvt_pk_bf16_f32 v177, v18, v19
    v_mul_f32 v20, v20, v192
    v_mul_f32 v21, v21, v192
    v_mul_f32 v22, v22, v192
    v_mul_f32 v23, v23, v192
    v_cvt_pk_bf16_f32 v178, v20, v21
    v_cvt_pk_bf16_f32 v179, v22, v23
    v_mul_f32 v24, v24, v192
    v_mul_f32 v25, v25, v192
    v_mul_f32 v26, v26, v192
    v_mul_f32 v27, v27, v192
    v_cvt_pk_bf16_f32 v180, v24, v25
    v_cvt_pk_bf16_f32 v181, v26, v27
    v_mul_f32 v28, v28, v192
    v_mul_f32 v29, v29, v192
    v_mul_f32 v30, v30, v192
    v_mul_f32 v31, v31, v192
    v_cvt_pk_bf16_f32 v182, v28, v29
    v_cvt_pk_bf16_f32 v183, v30, v31
    v_mul_f32 v32, v32, v193
    v_mul_f32 v33, v33, v193
    v_mul_f32 v34, v34, v193
    v_mul_f32 v35, v35, v193
    v_cvt_pk_bf16_f32 v184, v32, v33
    v_cvt_pk_bf16_f32 v185, v34, v35
    v_mul_f32 v36, v36, v193
    v_mul_f32 v37, v37, v193
    v_mul_f32 v38, v38, v193
    v_mul_f32 v39, v39, v193
    v_cvt_pk_bf16_f32 v186, v36, v37
    v_cvt_pk_bf16_f32 v187, v38, v39
    v_mul_f32 v40, v40, v193
    v_mul_f32 v41, v41, v193
    v_mul_f32 v42, v42, v193
    v_mul_f32 v43, v43, v193
    v_cvt_pk_bf16_f32 v188, v40, v41
    v_cvt_pk_bf16_f32 v189, v42, v43
    v_mul_f32 v44, v44, v193
    v_mul_f32 v45, v45, v193
    v_mul_f32 v46, v46, v193
    v_mul_f32 v47, v47, v193
    v_cvt_pk_bf16_f32 v190, v44, v45
    v_cvt_pk_bf16_f32 v191, v46, v47
    s_setprio 2
    v_and_b32 v52, 3, v253
    v_bfe_u32 v53, v253, 3, 1
    v_lshl_add_u32 v52, v53, 2, v52
    v_and_b32 v53, 1, v52
    v_lshlrev_b32 v53, 4, v53
    v_mov_b32 v54, 0x3f80
    v_lshlrev_b32 v53, v53, v54
    v_lshrrev_b32 v52, 1, v52
    v_bfe_u32 v54, v253, 2, 1
    v_xor_b32 v54, v54, v255
    v_lshrrev_b32 v55, 4, v253
    v_or_b32 v54, v54, v55
    v_lshl_add_u32 v52, v54, 2, v52
    s_lshl_b32 s28, s14, 14
    s_add_u32 s28, s28, s42
    s_add_u32 s41, s40, 20480
    s_lshl_b32 s29, s14, 10
    v_add_u32 v55, s29, v251
    v_cmp_eq_u32 vcc, 0, v52
    s_nop 1
    v_cndmask_b32 v48, 0, v53, vcc
    v_cmp_eq_u32 vcc, 1, v52
    s_nop 1
    v_cndmask_b32 v49, 0, v53, vcc
    v_cmp_eq_u32 vcc, 2, v52
    s_nop 1
    v_cndmask_b32 v50, 0, v53, vcc
    v_cmp_eq_u32 vcc, 3, v52
    s_nop 1
    v_cndmask_b32 v51, 0, v53, vcc
    s_cmp_lg_u32 s14, 3
    s_cbranch_scc1 A_S1_OK
    s_mov_b32 s60, 0
    s_mov_b64 exec, 1
POLL_10:
    buffer_load_dword v249, v248, s[32:35], s41 offen sc1
    s_add_u32 s60, s60, 1
    s_waitcnt vmcnt(0)
    v_readfirstlane_b32 s61, v249
    s_cmp_ge_u32 s61, 1
    s_cbranch_scc1 POLLD_11
    s_sleep 1
    s_cmp_lt_u32 s60, 0x40000
    s_cbranch_scc1 POLL_10
POLLD_11:
    s_mov_b64 exec, -1
A_S1_OK:
    s_barrier
    buffer_load_dwordx4 v[64:67], v251, s[32:35], s28 offen offset:0 sc1
    buffer_load_dwordx4 v[68:71], v251, s[32:35], s28 offen offset:1024 sc1
    buffer_load_dwordx4 v[72:75], v251, s[32:35], s28 offen offset:2048 sc1
    buffer_load_dwordx4 v[76:79], v251, s[32:35], s28 offen offset:3072 sc1
    s_add_u32 s28, s28, 4096
    buffer_load_dwordx4 v[80:83], v251, s[32:35], s28 offen offset:0 sc1
    buffer_load_dwordx4 v[84:87], v251, s[32:35], s28 offen offset:1024 sc1
    buffer_load_dwordx4 v[88:91], v251, s[32:35], s28 offen offset:2048 sc1
    buffer_load_dwordx4 v[92:95], v251, s[32:35], s28 offen offset:3072 sc1
    s_add_u32 s28, s28, 4096
    buffer_load_dwordx4 v[96:99], v251, s[32:35], s28 offen offset:0 sc1
    buffer_load_dwordx4 v[100:103], v251, s[32:35], s28 offen offset:1024 sc1
    buffer_load_dwordx4 v[104:107], v251, s[32:35], s28 offen offset:2048 sc1
    buffer_load_dwordx4 v[108:111], v251, s[32:35], s28 offen offset:3072 sc1
    s_add_u32 s28, s28, 4096
    buffer_load_dwordx4 v[112:115], v251, s[32:35], s28 offen offset:0 sc1
    buffer_load_dwordx4 v[116:119], v251, s[32:35], s28 offen offset:1024 sc1
    buffer_load_dwordx4 v[120:123], v251, s[32:35], s28 offen offset:2048 sc1
    buffer_load_dwordx4 v[124:127], v251, s[32:35], s28 offen offset:3072 sc1
    s_lshl_b32 s28, s36, 15
    s_lshl_b32 s29, s39, 11
    s_add_u32 s28, s28, s29
    s_add_u32 s28, s28, 0x900000
    s_lshr_b32 s40, s36, 1
    s_lshl_b32 s40, s40, 8
    s_add_u32 s40, s40, 0x840000
    s_waitcnt vmcnt(15)
    v_mfma_f32_32x32x16_bf16 v[0:15], v[48:51], v[64:67], 0
    s_waitcnt vmcnt(14)
    v_mfma_f32_32x32x16_bf16 v[0:15], v[48:51], v[68:71], v[0:15]
    s_waitcnt vmcnt(13)
    v_mfma_f32_32x32x16_bf16 v[0:15], v[48:51], v[72:75], v[0:15]
    s_waitcnt vmcnt(12)
    v_mfma_f32_32x32x16_bf16 v[0:15], v[48:51], v[76:79], v[0:15]
    s_waitcnt vmcnt(11)
    v_mfma_f32_32x32x16_bf16 v[0:15], v[48:51], v[80:83], v[0:15]
    s_waitcnt vmcnt(10)
    v_mfma_f32_32x32x16_bf16 v[0:15], v[48:51], v[84:87], v[0:15]
    s_waitcnt vmcnt(9)
    v_mfma_f32_32x32x16_bf16 v[0:15], v[48:51], v[88:91], v[0:15]
    s_waitcnt vmcnt(8)
    v_mfma_f32_32x32x16_bf16 v[0:15], v[48:51], v[92:95], v[0:15]
    s_waitcnt vmcnt(7)
    v_mfma_f32_32x32x16_bf16 v[0:15], v[48:51], v[96:99], v[0:15]
    s_waitcnt vmcnt(6)
    v_mfma_f32_32x32x16_bf16 v[0:15], v[48:51], v[100:103], v[0:15]
    s_waitcnt vmcnt(5)
    v_mfma_f32_32x32x16_bf16 v[0:15], v[48:51], v[104:107], v[0:15]
    s_waitcnt vmcnt(4)
    v_mfma_f32_32x32x16_bf16 v[0:15], v[48:51], v[108:111], v[0:15]
    s_waitcnt vmcnt(3)
    v_mfma_f32_32x32x16_bf16 v[0:15], v[48:51], v[112:115], v[0:15]
    s_waitcnt vmcnt(2)
    v_mfma_f32_32x32x16_bf16 v[0:15], v[48:51], v[116:119], v[0:15]
    s_waitcnt vmcnt(1)
    v_mfma_f32_32x32x16_bf16 v[0:15], v[48:51], v[120:123], v[0:15]
    s_waitcnt vmcnt(0)
    v_mfma_f32_32x32x16_bf16 v[0:15], v[48:51], v[124:127], v[0:15]
    s_nop 11
    v_cvt_pk_bf16_f32 v16, v0, v1
    v_cvt_pk_bf16_f32 v17, v2, v3
    v_cvt_pk_bf16_f32 v18, v4, v5
    v_cvt_pk_bf16_f32 v19, v6, v7
    ds_write_b128 v55, v[16:19]
    s_waitcnt lgkmcnt(0)
    s_barrier
    ds_read_b128 v[16:19], v251 offset:0
    ds_read_b128 v[20:23], v251 offset:1024
    ds_read_b128 v[24:27], v251 offset:2048
    ds_read_b128 v[28:31], v251 offset:3072
    s_waitcnt lgkmcnt(3)
    v_mfma_f32_32x32x16_bf16 v[32:47], v[16:19], v[176:179], 0
    s_waitcnt lgkmcnt(2)
    v_mfma_f32_32x32x16_bf16 v[32:47], v[20:23], v[180:183], v[32:47]
    s_waitcnt lgkmcnt(1)
    v_mfma_f32_32x32x16_bf16 v[32:47], v[24:27], v[184:187], v[32:47]
    s_waitcnt lgkmcnt(0)
    v_mfma_f32_32x32x16_bf16 v[32:47], v[28:31], v[188:191], v[32:47]
    s_nop 11
    v_mov_b32 v0, v44
    v_mov_b32 v2, v44
    s_nop 1
    v_permlane32_swap_b32 v0, v2
    s_nop 0
    v_add_f32 v2, 0x358637bd, v2
    v_rcp_f32 v2, v2
    s_nop 0
    v_mul_f32 v32, v32, v2
    v_mul_f32 v33, v33, v2
    v_mul_f32 v34, v34, v2
    v_mul_f32 v35, v35, v2
    v_mul_f32 v36, v36, v2
    v_mul_f32 v37, v37, v2
    v_mul_f32 v38, v38, v2
    v_mul_f32 v39, v39, v2
    v_cvt_pk_bf16_f32 v16, v32, v33
    v_cvt_pk_bf16_f32 v17, v34, v35
    v_cvt_pk_bf16_f32 v18, v36, v37
    v_cvt_pk_bf16_f32 v19, v38, v39
    buffer_store_dwordx4 v[16:19], v251, s[32:35], s28 offen offset:0 sc1
    v_mul_f32 v40, v40, v2
    v_mul_f32 v41, v41, v2
    v_mul_f32 v42, v42, v2
    v_mul_f32 v43, v43, v2
    v_mul_f32 v44, v44, v2
    v_mul_f32 v45, v45, v2
    v_mul_f32 v46, v46, v2
    v_mul_f32 v47, v47, v2
    v_cvt_pk_bf16_f32 v20, v40, v41
    v_cvt_pk_bf16_f32 v21, v42, v43
    v_cvt_pk_bf16_f32 v22, v44, v45
    v_cvt_pk_bf16_f32 v23, v46, v47
    buffer_store_dwordx4 v[20:23], v251, s[32:35], s28 offen offset:1024 sc1
    s_waitcnt vmcnt(0)
    s_mov_b32 s62, 1
    s_atomic_add s62, s[30:31], s40 offset:32768 glc
    s_waitcnt lgkmcnt(0)
    s_cmp_lg_u32 s62, 31
    s_cbranch_scc1 A_FIN
    s_mov_b32 s62, 1
    s_atomic_add s62, s[30:31], s40 offset:40960
A_FIN:
    s_endpgm
G_SETUP:
    s_mov_b32 s36, s42
    s_and_b32 s37, s43, 0xffff
    s_mov_b32 s38, 3584
    s_mov_b32 s39, 0x20000
    buffer_load_dwordx2 v[192:193], v251, s[36:39], s60 offen offset:0
    buffer_load_dwordx2 v[194:195], v251, s[36:39], s60 offen offset:16
    buffer_load_dwordx2 v[196:197], v251, s[36:39], s60 offen offset:32
    buffer_load_dwordx2 v[198:199], v251, s[36:39], s60 offen offset:48
    s_mov_b32 s32, s30
    s_and_b32 s33, s31, 0xffff
    s_mov_b32 s34, 0x1000000
    s_mov_b32 s35, 0x20000
    s_setprio 1
    v_lshlrev_b32 v239, 4, v238
    v_mov_b32 v250, 0
    s_lshr_b32 s60, s14, 1
    s_lshl_b32 s60, s60, 5
    s_lshl_b32 s61, s66, 6
    s_add_u32 s60, s60, s61
    v_and_b32 v252, 31, v238
    v_add_u32 v252, s60, v252
    v_mul_u32_u24 v248, 896, v252
    v_lshlrev_b32 v253, 1, v251
    s_lshl_b32 s60, s64, 7
    s_and_b32 s61, s14, 1
    s_lshl_b32 s61, s61, 6
    s_add_u32 s60, s60, s61
    v_add3_u32 v248, v248, v253, s60
    v_lshlrev_b32 v249, 1, v252
    s_and_b32 s60, s14, 1
    s_lshl_b32 s60, s60, 10
    v_add_u32 v234, s60, v239
    v_xor_b32 v235, 0x400, v234
    s_lshl_b32 s68, s64, 18
    s_add_u32 s68, s68, 0x200000
    s_mul_i32 s60, s64, 294912
    s_add_u32 s60, s60, 0x600000
    s_add_u32 s40, s30, s60
    s_addc_u32 s41, s31, 0
    s_and_b32 s41, s41, 0xffff
    s_mov_b32 s42, 294912
    s_mov_b32 s43, 0x20000
    s_mov_b32 s44, s28
    s_and_b32 s45, s29, 0xffff
    s_mov_b32 s46, 256
    s_mov_b32 s47, 0x20000
    s_mov_b32 s24, s52
    s_and_b32 s25, s53, 0xffff
    s_mov_b32 s26, 7340032
    s_mov_b32 s27, 0x20000
    s_add_u32 s20, s30, s68
    s_addc_u32 s21, s31, 0
    s_and_b32 s21, s21, 0xffff
    s_mov_b32 s22, 262144
    s_mov_b32 s23, 0x20000
    global_load_ushort v249, v249, s[54:55]
    s_movk_i32 s68, 0x80
    s_cmp_lt_u32 s56, 7
    s_cbranch_scc1 G_TILE1
    s_mov_b32 s60, 0
    s_mov_b64 exec, 1
POLL_12:
    buffer_load_dword v251, v250, s[44:47], s68 offen sc1
    s_add_u32 s60, s60, 1
    s_waitcnt vmcnt(0)
    v_readfirstlane_b32 s61, v251
    s_cmp_ge_u32 s61, 1
    s_cbranch_scc1 POLLD_13
    s_sleep 8
    s_cmp_lt_u32 s60, 0x40000
    s_cbranch_scc1 POLL_12
POLLD_13:
    s_mov_b64 exec, -1
    s_setprio 0
    s_lshl_b32 s58, s57, 2
    s_add_u32 s58, s58, s14
    s_lshl_b32 s58, s58, 10
    s_add_u32 s58, s58, 3670016
M_W2:
    s_waitcnt vmcnt(7)
    buffer_load_dwordx4 v[200:203], v239, s[24:27], s58 offen
    s_add_u32 s58, s58, 114688
    s_waitcnt vmcnt(7)
    buffer_load_dwordx4 v[204:207], v239, s[24:27], s58 offen
    s_add_u32 s58, s58, 114688
    s_waitcnt vmcnt(7)
    buffer_load_dwordx4 v[208:211], v239, s[24:27], s58 offen
    s_add_u32 s58, s58, 114688
    s_waitcnt vmcnt(7)
    buffer_load_dwordx4 v[212:215], v239, s[24:27], s58 offen
    s_add_u32 s58, s58, 114688
    s_cmp_lt_u32 s58, 7340032
    s_cbranch_scc1 M_W2
    s_setprio 1
    s_mov_b32 s69, 0x843f00
    s_mov_b32 s60, 0
    s_mov_b64 exec, 1
POLL_14:
    buffer_load_dword v251, v250, s[32:35], s69 offen sc1
    s_add_u32 s60, s60, 1
    s_waitcnt vmcnt(0)
    v_readfirstlane_b32 s61, v251
    s_cmp_ge_u32 s61, 1
    s_cbranch_scc1 POLLD_15
    s_sleep 8
    s_cmp_lt_u32 s60, 0x40000
    s_cbranch_scc1 POLL_14
POLLD_15:
    s_mov_b64 exec, -1
    v_lshrrev_b32 v252, 3, v238
    v_mul_u32_u24 v232, 4096, v252
    v_lshrrev_b32 v253, 2, v238
    v_and_b32 v253, 4, v253
    v_and_b32 v254, 7, v238
    v_xor_b32 v253, v253, v254
    v_lshl_add_u32 v232, v253, 4, v232
    v_add_u32 v232, s67, v232
    v_add_u32 v233, 32768, v232
    v_bfe_u32 v252, v238, 4, 1
    v_lshrrev_b32 v253, 5, v238
    v_lshlrev_b32 v236, 9, v253
    v_lshl_add_u32 v236, v252, 5, v236
    v_bfe_u32 v253, v238, 2, 2
    v_lshl_add_u32 v236, v253, 7, v236
    v_lshrrev_b32 v253, 1, v253
    v_lshl_add_u32 v236, v253, 6, v236
    v_and_b32 v253, 3, v238
    v_lshl_add_u32 v236, v253, 3, v236
    s_lshl_b32 s36, s14, 5
    s_and_b32 s36, s36, 64
    v_xor_b32 v236, s36, v236
    v_add_u32 v236, s50, v236
    v_xor_b32 v237, 64, v236
    s_lshl_b32 s6, s64, 4
    s_add_u32 s7, s6, 16
    s_cmp_ge_u32 s7, 112
    s_cselect_b32 s7, 0, s7
    s_add_u32 s8, s7, 16
    s_cmp_ge_u32 s8, 112
    s_cselect_b32 s8, 0, s8
    s_add_u32 s9, s8, 16
    s_cmp_ge_u32 s9, 112
    s_cselect_b32 s9, 0, s9
    s_add_u32 s10, s9, 16
    s_cmp_ge_u32 s10, 112
    s_cselect_b32 s10, 0, s10
    s_add_u32 s11, s10, 16
    s_cmp_ge_u32 s11, 112
    s_cselect_b32 s11, 0, s11
    s_add_u32 s48, s11, 16
    s_cmp_ge_u32 s48, 112
    s_cselect_b32 s48, 0, s48
    s_movk_i32 s49, 112
    s_lshl_b32 s61, s66, 2
    s_add_u32 s51, s61, 0
    s_and_b32 s51, s51, 12
    s_add_u32 s51, s51, s14
    s_add_u32 s15, s61, 4
    s_and_b32 s15, s15, 12
    s_add_u32 s15, s15, s14
    s_add_u32 s59, s61, 8
    s_and_b32 s59, s59, 12
    s_add_u32 s59, s59, s14
    s_add_u32 s3, s61, 12
    s_and_b32 s3, s3, 12
    s_add_u32 s3, s3, s14
    s_mov_b32 s65, 1
    s_branch G_JOIN
G_TILE1:
    s_lshl_b32 s6, s64, 4
    s_add_u32 s7, s6, 16
    s_cmp_ge_u32 s7, 112
    s_cselect_b32 s7, 0, s7
    s_add_u32 s8, s7, 16
    s_cmp_ge_u32 s8, 112
    s_cselect_b32 s8, 0, s8
    s_add_u32 s9, s8, 16
    s_cmp_ge_u32 s9, 112
    s_cselect_b32 s9, 0, s9
    s_add_u32 s10, s9, 16
    s_cmp_ge_u32 s10, 112
    s_cselect_b32 s10, 0, s10
    s_add_u32 s11, s10, 16
    s_cmp_ge_u32 s11, 112
    s_cselect_b32 s11, 0, s11
    s_add_u32 s48, s11, 16
    s_cmp_ge_u32 s48, 112
    s_cselect_b32 s48, 0, s48
    s_movk_i32 s49, 112
    v_bfe_u32 v252, v238, 4, 1
    v_lshrrev_b32 v253, 5, v238
    v_lshlrev_b32 v236, 10, v253
    v_lshl_add_u32 v236, v252, 5, v236
    v_bfe_u32 v253, v238, 2, 2
    v_lshl_add_u32 v236, v253, 7, v236
    v_lshrrev_b32 v253, 1, v253
    v_lshl_add_u32 v236, v253, 6, v236
    v_and_b32 v253, 3, v238
    v_lshl_add_u32 v236, v253, 3, v236
    s_lshl_b32 s36, s14, 5
    s_and_b32 s36, s36, 64
    v_xor_b32 v236, s36, v236
    v_add_u32 v236, s50, v236
    v_xor_b32 v237, 64, v236
    s_waitcnt vmcnt(0)
    s_add_u32 s58, s7, s51
    s_add_u32 m0, s50, 8192
    s_mul_i32 s58, s58, 57344
    buffer_load_dwordx4 v232, s[16:19], s58 offen  lds
    s_add_u32 m0, s50, 9216
    s_nop 0
    buffer_load_dwordx4 v233, s[16:19], s58 offen  lds
    s_add_u32 s58, s7, s15
    s_add_u32 m0, s50, 10240
    s_mul_i32 s58, s58, 57344
    buffer_load_dwordx4 v232, s[16:19], s58 offen  lds
    s_add_u32 m0, s50, 11264
    s_nop 0
    buffer_load_dwordx4 v233, s[16:19], s58 offen  lds
    s_add_u32 s58, s7, s59
    s_add_u32 m0, s50, 12288
    s_mul_i32 s58, s58, 57344
    buffer_load_dwordx4 v232, s[16:19], s58 offen  lds
    s_add_u32 m0, s50, 13312
    s_nop 0
    buffer_load_dwordx4 v233, s[16:19], s58 offen  lds
    s_add_u32 s58, s7, s3
    s_add_u32 m0, s50, 14336
    s_mul_i32 s58, s58, 57344
    buffer_load_dwordx4 v232, s[16:19], s58 offen  lds
    s_add_u32 m0, s50, 15360
    s_nop 0
    buffer_load_dwordx4 v233, s[16:19], s58 offen  lds
    ds_read_b64_tr_b16 v[64:65], v236 offset:0
    ds_read_b64_tr_b16 v[66:67], v236 offset:512
    ds_read_b64_tr_b16 v[68:69], v237 offset:0
    ds_read_b64_tr_b16 v[70:71], v237 offset:512
    ds_read_b64_tr_b16 v[72:73], v236 offset:2048
    ds_read_b64_tr_b16 v[74:75], v236 offset:2560
    ds_read_b64_tr_b16 v[76:77], v237 offset:2048
    ds_read_b64_tr_b16 v[78:79], v237 offset:2560
    ds_read_b64_tr_b16 v[80:81], v236 offset:4096
    ds_read_b64_tr_b16 v[82:83], v236 offset:4608
    ds_read_b64_tr_b16 v[84:85], v237 offset:4096
    ds_read_b64_tr_b16 v[86:87], v237 offset:4608
    ds_read_b64_tr_b16 v[88:89], v236 offset:6144
    ds_read_b64_tr_b16 v[90:91], v236 offset:6656
    ds_read_b64_tr_b16 v[92:93], v237 offset:6144
    ds_read_b64_tr_b16 v[94:95], v237 offset:6656
    s_waitcnt vmcnt(6)
    ds_read_b64_tr_b16 v[96:97], v236 offset:8192
    ds_read_b64_tr_b16 v[98:99], v236 offset:8704
    ds_read_b64_tr_b16 v[100:101], v237 offset:8192
    ds_read_b64_tr_b16 v[102:103], v237 offset:8704
    s_add_u32 s58, s8, s51
    s_add_u32 m0, s50, 16384
    s_mul_i32 s58, s58, 57344
    buffer_load_dwordx4 v232, s[16:19], s58 offen  lds
    s_add_u32 m0, s50, 17408
    s_nop 0
    buffer_load_dwordx4 v233, s[16:19], s58 offen  lds
    s_waitcnt vmcnt(6)
    ds_read_b64_tr_b16 v[104:105], v236 offset:10240
    ds_read_b64_tr_b16 v[106:107], v236 offset:10752
    ds_read_b64_tr_b16 v[108:109], v237 offset:10240
    ds_read_b64_tr_b16 v[110:111], v237 offset:10752
    s_add_u32 s58, s8, s15
    s_add_u32 m0, s50, 18432
    s_mul_i32 s58, s58, 57344
    buffer_load_dwordx4 v232, s[16:19], s58 offen  lds
    s_add_u32 m0, s50, 19456
    s_nop 0
    buffer_load_dwordx4 v233, s[16:19], s58 offen  lds
    s_waitcnt vmcnt(6)
    ds_read_b64_tr_b16 v[112:113], v236 offset:12288
    ds_read_b64_tr_b16 v[114:115], v236 offset:12800
    ds_read_b64_tr_b16 v[116:117], v237 offset:12288
    ds_read_b64_tr_b16 v[118:119], v237 offset:12800
    s_waitcnt lgkmcnt(15)
    s_add_u32 s58, s8, s59
    s_add_u32 m0, s50, 0
    s_mul_i32 s58, s58, 57344
    buffer_load_dwordx4 v232, s[16:19], s58 offen  lds
    s_add_u32 m0, s50, 1024
    s_nop 0
    buffer_load_dwordx4 v233, s[16:19], s58 offen  lds
    s_waitcnt vmcnt(6)
    ds_read_b64_tr_b16 v[120:121], v236 offset:14336
    ds_read_b64_tr_b16 v[122:123], v236 offset:14848
    ds_read_b64_tr_b16 v[124:125], v237 offset:14336
    ds_read_b64_tr_b16 v[126:127], v237 offset:14848
    s_add_u32 s58, s8, s3
    s_add_u32 m0, s50, 2048
    s_mul_i32 s58, s58, 57344
    buffer_load_dwordx4 v232, s[16:19], s58 offen  lds
    s_add_u32 m0, s50, 3072
    s_nop 0
    buffer_load_dwordx4 v233, s[16:19], s58 offen  lds
    s_waitcnt vmcnt(6)
    ds_read_b64_tr_b16 v[128:129], v236 offset:16384
    ds_read_b64_tr_b16 v[130:131], v236 offset:16896
    ds_read_b64_tr_b16 v[132:133], v237 offset:16384
    ds_read_b64_tr_b16 v[134:135], v237 offset:16896
    s_add_u32 s58, s9, s51
    s_add_u32 m0, s50, 4096
    s_mul_i32 s58, s58, 57344
    buffer_load_dwordx4 v232, s[16:19], s58 offen  lds
    s_add_u32 m0, s50, 5120
    s_nop 0
    buffer_load_dwordx4 v233, s[16:19], s58 offen  lds
    s_waitcnt vmcnt(6)
    ds_read_b64_tr_b16 v[136:137], v236 offset:18432
    ds_read_b64_tr_b16 v[138:139], v236 offset:18944
    ds_read_b64_tr_b16 v[140:141], v237 offset:18432
    ds_read_b64_tr_b16 v[142:143], v237 offset:18944
    s_waitcnt lgkmcnt(15)
    s_add_u32 s58, s9, s15
    s_add_u32 m0, s50, 6144
    s_mul_i32 s58, s58, 57344
    buffer_load_dwordx4 v232, s[16:19], s58 offen  lds
    s_add_u32 m0, s50, 7168
    s_nop 0
    buffer_load_dwordx4 v233, s[16:19], s58 offen  lds
    s_waitcnt vmcnt(6)
    ds_read_b64_tr_b16 v[144:145], v236 offset:0
    ds_read_b64_tr_b16 v[146:147], v236 offset:512
    ds_read_b64_tr_b16 v[148:149], v237 offset:0
    ds_read_b64_tr_b16 v[150:151], v237 offset:512
    s_add_u32 s58, s9, s59
    s_add_u32 m0, s50, 8192
    s_mul_i32 s58, s58, 57344
    buffer_load_dwordx4 v232, s[16:19], s58 offen  lds
    s_add_u32 m0, s50, 9216
    s_nop 0
    buffer_load_dwordx4 v233, s[16:19], s58 offen  lds
    s_waitcnt vmcnt(6)
    ds_read_b64_tr_b16 v[152:153], v236 offset:2048
    ds_read_b64_tr_b16 v[154:155], v236 offset:2560
    ds_read_b64_tr_b16 v[156:157], v237 offset:2048
    ds_read_b64_tr_b16 v[158:159], v237 offset:2560
    s_add_u32 s58, s9, s3
    s_add_u32 m0, s50, 10240
    s_mul_i32 s58, s58, 57344
    buffer_load_dwordx4 v232, s[16:19], s58 offen  lds
    s_add_u32 m0, s50, 11264
    s_nop 0
    buffer_load_dwordx4 v233, s[16:19], s58 offen  lds
    s_waitcnt vmcnt(6)
    ds_read_b64_tr_b16 v[160:161], v236 offset:4096
    ds_read_b64_tr_b16 v[162:163], v236 offset:4608
    ds_read_b64_tr_b16 v[164:165], v237 offset:4096
    ds_read_b64_tr_b16 v[166:167], v237 offset:4608
    s_waitcnt lgkmcnt(15)
    s_add_u32 s58, s10, s51
    s_add_u32 m0, s50, 12288
    s_mul_i32 s58, s58, 57344
    buffer_load_dwordx4 v232, s[16:19], s58 offen  lds
    s_add_u32 m0, s50, 13312
    s_nop 0
    buffer_load_dwordx4 v233, s[16:19], s58 offen  lds
    s_waitcnt vmcnt(6)
    ds_read_b64_tr_b16 v[168:169], v236 offset:6144
    ds_read_b64_tr_b16 v[170:171], v236 offset:6656
    ds_read_b64_tr_b16 v[172:173], v237 offset:6144
    ds_read_b64_tr_b16 v[174:175], v237 offset:6656
    s_add_u32 s58, s10, s15
    s_add_u32 m0, s50, 14336
    s_mul_i32 s58, s58, 57344
    buffer_load_dwordx4 v232, s[16:19], s58 offen  lds
    s_add_u32 m0, s50, 15360
    s_nop 0
    buffer_load_dwordx4 v233, s[16:19], s58 offen  lds
    s_waitcnt vmcnt(6)
    ds_read_b64_tr_b16 v[176:177], v236 offset:8192
    ds_read_b64_tr_b16 v[178:179], v236 offset:8704
    ds_read_b64_tr_b16 v[180:181], v237 offset:8192
    ds_read_b64_tr_b16 v[182:183], v237 offset:8704
    s_add_u32 s58, s10, s59
    s_add_u32 m0, s50, 16384
    s_mul_i32 s58, s58, 57344
    buffer_load_dwordx4 v232, s[16:19], s58 offen  lds
    s_add_u32 m0, s50, 17408
    s_nop 0
    buffer_load_dwordx4 v233, s[16:19], s58 offen  lds
    s_waitcnt vmcnt(6)
    ds_read_b64_tr_b16 v[184:185], v236 offset:10240
    ds_read_b64_tr_b16 v[186:187], v236 offset:10752
    ds_read_b64_tr_b16 v[188:189], v237 offset:10240
    ds_read_b64_tr_b16 v[190:191], v237 offset:10752
    s_waitcnt lgkmcnt(15)
    s_add_u32 s58, s10, s3
    s_add_u32 m0, s50, 18432
    s_mul_i32 s58, s58, 57344
    buffer_load_dwordx4 v232, s[16:19], s58 offen  lds
    s_add_u32 m0, s50, 19456
    s_nop 0
    buffer_load_dwordx4 v233, s[16:19], s58 offen  lds
    s_waitcnt vmcnt(6)
    s_add_u32 s58, s11, s51
    s_add_u32 m0, s50, 0
    s_mul_i32 s58, s58, 57344
    buffer_load_dwordx4 v232, s[16:19], s58 offen  lds
    s_add_u32 m0, s50, 1024
    s_nop 0
    buffer_load_dwordx4 v233, s[16:19], s58 offen  lds
    s_waitcnt vmcnt(6)
    s_add_u32 s58, s11, s15
    s_add_u32 m0, s50, 2048
    s_mul_i32 s58, s58, 57344
    buffer_load_dwordx4 v232, s[16:19], s58 offen  lds
    s_add_u32 m0, s50, 3072
    s_nop 0
    buffer_load_dwordx4 v233, s[16:19], s58 offen  lds
    s_waitcnt vmcnt(6)
    s_waitcnt lgkmcnt(12)
    s_add_u32 s58, s11, s59
    s_add_u32 m0, s50, 4096
    s_mul_i32 s58, s58, 57344
    buffer_load_dwordx4 v232, s[16:19], s58 offen  lds
    s_add_u32 m0, s50, 5120
    s_nop 0
    buffer_load_dwordx4 v233, s[16:19], s58 offen  lds
    s_waitcnt vmcnt(6)
    s_waitcnt lgkmcnt(8)
    s_add_u32 s58, s11, s3
    s_add_u32 m0, s50, 6144
    s_mul_i32 s58, s58, 57344
    buffer_load_dwordx4 v232, s[16:19], s58 offen  lds
    s_add_u32 m0, s50, 7168
    s_nop 0
    buffer_load_dwordx4 v233, s[16:19], s58 offen  lds
    s_waitcnt vmcnt(6)
    buffer_load_dword v251, v250, s[44:47], s68 offen sc1
    v_lshlrev_b32 v0, 16, v192
    v_and_b32 v1, 0xffff0000, v192
    v_lshlrev_b32 v2, 16, v193
    v_and_b32 v3, 0xffff0000, v193
    v_lshlrev_b32 v4, 16, v194
    v_and_b32 v5, 0xffff0000, v194
    v_lshlrev_b32 v6, 16, v195
    v_and_b32 v7, 0xffff0000, v195
    v_lshlrev_b32 v8, 16, v196
    v_and_b32 v9, 0xffff0000, v196
    v_lshlrev_b32 v10, 16, v197
    v_and_b32 v11, 0xffff0000, v197
    v_lshlrev_b32 v12, 16, v198
    v_and_b32 v13, 0xffff0000, v198
    v_lshlrev_b32 v14, 16, v199
    v_and_b32 v15, 0xffff0000, v199
    s_waitcnt lgkmcnt(4)
    s_add_u32 s58, s48, s51
    s_add_u32 m0, s50, 8192
    s_mul_i32 s58, s58, 57344
    buffer_load_dwordx4 v232, s[16:19], s58 offen  lds
    s_add_u32 m0, s50, 9216
    s_nop 0
    buffer_load_dwordx4 v233, s[16:19], s58 offen  lds
    s_waitcnt vmcnt(7)
    s_waitcnt lgkmcnt(0)
    s_add_u32 s58, s48, s15
    s_add_u32 m0, s50, 10240
    s_mul_i32 s58, s58, 57344
    buffer_load_dwordx4 v232, s[16:19], s58 offen  lds
    s_add_u32 m0, s50, 11264
    s_nop 0
    buffer_load_dwordx4 v233, s[16:19], s58 offen  lds
    s_waitcnt vmcnt(4)
    v_readfirstlane_b32 s61, v251
    s_cmp_lg_u32 s61, 0
    s_cbranch_scc1 FLAG_16
    s_mov_b32 s60, 0
    s_mov_b64 exec, 1
POLL_17:
    buffer_load_dword v251, v250, s[44:47], s68 offen sc1
    s_add_u32 s60, s60, 1
    s_waitcnt vmcnt(0)
    v_readfirstlane_b32 s61, v251
    s_cmp_ge_u32 s61, 1
    s_cbranch_scc1 POLLD_18
    s_sleep 2
    s_cmp_lt_u32 s60, 0x40000
    s_cbranch_scc1 POLL_17
POLLD_18:
    s_mov_b64 exec, -1
FLAG_16:
    s_add_u32 s60, s6, s51
    s_lshl_b32 s60, s60, 11
    buffer_load_dwordx4 v[192:195], v234, s[20:23], s60 offen sc1
    buffer_load_dwordx4 v[196:199], v235, s[20:23], s60 offen sc1
    s_add_u32 s60, s6, s15
    s_lshl_b32 s60, s60, 11
    buffer_load_dwordx4 v[200:203], v234, s[20:23], s60 offen sc1
    buffer_load_dwordx4 v[204:207], v235, s[20:23], s60 offen sc1
    s_add_u32 s60, s6, s59
    s_lshl_b32 s60, s60, 11
    buffer_load_dwordx4 v[208:211], v234, s[20:23], s60 offen sc1
    buffer_load_dwordx4 v[212:215], v235, s[20:23], s60 offen sc1
    s_add_u32 s60, s6, s3
    s_lshl_b32 s60, s60, 11
    buffer_load_dwordx4 v[216:219], v234, s[20:23], s60 offen sc1
    buffer_load_dwordx4 v[220:223], v235, s[20:23], s60 offen sc1
    s_add_u32 s60, s7, s51
    s_lshl_b32 s60, s60, 11
    buffer_load_dwordx4 v[224:227], v234, s[20:23], s60 offen sc1
    buffer_load_dwordx4 v[228:231], v235, s[20:23], s60 offen sc1
    s_add_u32 s60, s7, s15
    s_lshl_b32 s60, s60, 11
    buffer_load_dwordx4 v[240:243], v234, s[20:23], s60 offen sc1
    buffer_load_dwordx4 v[244:247], v235, s[20:23], s60 offen sc1
    s_waitcnt vmcnt(10)
    v_mfma_f32_32x32x16_bf16 v[0:15], v[64:67], v[192:195], v[0:15]
    v_mfma_f32_32x32x16_bf16 v[16:31], v[64:67], v[196:199], 0
    v_mfma_f32_32x32x16_bf16 v[32:47], v[68:71], v[192:195], 0
    v_mfma_f32_32x32x16_bf16 v[48:63], v[68:71], v[196:199], 0
    s_waitcnt vmcnt(8)
    v_mfma_f32_32x32x16_bf16 v[0:15], v[72:75], v[200:203], v[0:15]
    s_add_u32 s60, s7, s59
    s_lshl_b32 s60, s60, 11
    buffer_load_dwordx4 v[192:195], v234, s[20:23], s60 offen sc1
    v_mfma_f32_32x32x16_bf16 v[16:31], v[72:75], v[204:207], v[16:31]
    buffer_load_dwordx4 v[196:199], v235, s[20:23], s60 offen sc1
    v_mfma_f32_32x32x16_bf16 v[32:47], v[76:79], v[200:203], v[32:47]
    ds_read_b64_tr_b16 v[64:65], v236 offset:12288
    ds_read_b64_tr_b16 v[66:67], v236 offset:12800
    v_mfma_f32_32x32x16_bf16 v[48:63], v[76:79], v[204:207], v[48:63]
    ds_read_b64_tr_b16 v[68:69], v237 offset:12288
    ds_read_b64_tr_b16 v[70:71], v237 offset:12800
    s_waitcnt vmcnt(8)
    v_mfma_f32_32x32x16_bf16 v[0:15], v[80:83], v[208:211], v[0:15]
    s_add_u32 s60, s7, s3
    s_lshl_b32 s60, s60, 11
    buffer_load_dwordx4 v[200:203], v234, s[20:23], s60 offen sc1
    buffer_load_dwordx4 v[204:207], v235, s[20:23], s60 offen sc1
    v_mfma_f32_32x32x16_bf16 v[16:31], v[80:83], v[212:215], v[16:31]
    ds_read_b64_tr_b16 v[72:73], v236 offset:14336
    ds_read_b64_tr_b16 v[74:75], v236 offset:14848
    v_mfma_f32_32x32x16_bf16 v[32:47], v[84:87], v[208:211], v[32:47]
    ds_read_b64_tr_b16 v[76:77], v237 offset:14336
    ds_read_b64_tr_b16 v[78:79], v237 offset:14848
    s_waitcnt lgkmcnt(4)
    s_add_u32 s58, s48, s59
    s_add_u32 m0, s50, 12288
    s_mul_i32 s58, s58, 57344
    buffer_load_dwordx4 v232, s[16:19], s58 offen  lds
    s_add_u32 m0, s50, 13312
    v_mfma_f32_32x32x16_bf16 v[48:63], v[84:87], v[212:215], v[48:63]
    s_nop 0
    buffer_load_dwordx4 v233, s[16:19], s58 offen  lds
    s_waitcnt vmcnt(10)
    v_mfma_f32_32x32x16_bf16 v[0:15], v[88:91], v[216:219], v[0:15]
    s_add_u32 s60, s8, s51
    s_lshl_b32 s60, s60, 11
    buffer_load_dwordx4 v[208:211], v234, s[20:23], s60 offen sc1
    buffer_load_dwordx4 v[212:215], v235, s[20:23], s60 offen sc1
    v_mfma_f32_32x32x16_bf16 v[16:31], v[88:91], v[220:223], v[16:31]
    ds_read_b64_tr_b16 v[80:81], v236 offset:16384
    ds_read_b64_tr_b16 v[82:83], v236 offset:16896
    v_mfma_f32_32x32x16_bf16 v[32:47], v[92:95], v[216:219], v[32:47]
    ds_read_b64_tr_b16 v[84:85], v237 offset:16384
    ds_read_b64_tr_b16 v[86:87], v237 offset:16896
    s_waitcnt lgkmcnt(4)
    s_add_u32 s58, s48, s3
    s_add_u32 m0, s50, 14336
    s_mul_i32 s58, s58, 57344
    buffer_load_dwordx4 v232, s[16:19], s58 offen  lds
    s_add_u32 m0, s50, 15360
    v_mfma_f32_32x32x16_bf16 v[48:63], v[92:95], v[220:223], v[48:63]
    s_nop 0
    buffer_load_dwordx4 v233, s[16:19], s58 offen  lds
    s_waitcnt vmcnt(12)
    v_mfma_f32_32x32x16_bf16 v[0:15], v[96:99], v[224:227], v[0:15]
    s_add_u32 s60, s8, s15
    s_lshl_b32 s60, s60, 11
    buffer_load_dwordx4 v[216:219], v234, s[20:23], s60 offen sc1
    buffer_load_dwordx4 v[220:223], v235, s[20:23], s60 offen sc1
    v_mfma_f32_32x32x16_bf16 v[16:31], v[96:99], v[228:231], v[16:31]
    ds_read_b64_tr_b16 v[88:89], v236 offset:18432
    ds_read_b64_tr_b16 v[90:91], v236 offset:18944
    v_mfma_f32_32x32x16_bf16 v[32:47], v[100:103], v[224:227], v[32:47]
    ds_read_b64_tr_b16 v[92:93], v237 offset:18432
    ds_read_b64_tr_b16 v[94:95], v237 offset:18944
    s_waitcnt lgkmcnt(4)
    s_add_u32 s58, s49, s51
    s_add_u32 m0, s50, 16384
    s_mul_i32 s58, s58, 57344
    buffer_load_dwordx4 v232, s[16:19], s58 offen  lds
    s_add_u32 m0, s50, 17408
    v_mfma_f32_32x32x16_bf16 v[48:63], v[100:103], v[228:231], v[48:63]
    s_nop 0
    buffer_load_dwordx4 v233, s[16:19], s58 offen  lds
    s_waitcnt vmcnt(14)
    v_mfma_f32_32x32x16_bf16 v[0:15], v[104:107], v[240:243], v[0:15]
    s_add_u32 s60, s8, s59
    s_lshl_b32 s60, s60, 11
    buffer_load_dwordx4 v[224:227], v234, s[20:23], s60 offen sc1
    buffer_load_dwordx4 v[228:231], v235, s[20:23], s60 offen sc1
    v_mfma_f32_32x32x16_bf16 v[16:31], v[104:107], v[244:247], v[16:31]
    ds_read_b64_tr_b16 v[96:97], v236 offset:0
    ds_read_b64_tr_b16 v[98:99], v236 offset:512
    v_mfma_f32_32x32x16_bf16 v[32:47], v[108:111], v[240:243], v[32:47]
    ds_read_b64_tr_b16 v[100:101], v237 offset:0
    ds_read_b64_tr_b16 v[102:103], v237 offset:512
    s_waitcnt lgkmcnt(4)
    s_add_u32 s58, s49, s15
    s_add_u32 m0, s50, 18432
    s_mul_i32 s58, s58, 57344
    buffer_load_dwordx4 v232, s[16:19], s58 offen  lds
    s_add_u32 m0, s50, 19456
    v_mfma_f32_32x32x16_bf16 v[48:63], v[108:111], v[244:247], v[48:63]
    s_nop 0
    buffer_load_dwordx4 v233, s[16:19], s58 offen  lds
    s_waitcnt vmcnt(16)
    v_mfma_f32_32x32x16_bf16 v[0:15], v[112:115], v[192:195], v[0:15]
    s_add_u32 s60, s8, s3
    s_lshl_b32 s60, s60, 11
    buffer_load_dwordx4 v[240:243], v234, s[20:23], s60 offen sc1
    buffer_load_dwordx4 v[244:247], v235, s[20:23], s60 offen sc1
    v_mfma_f32_32x32x16_bf16 v[16:31], v[112:115], v[196:199], v[16:31]
    ds_read_b64_tr_b16 v[104:105], v236 offset:2048
    ds_read_b64_tr_b16 v[106:107], v236 offset:2560
    v_mfma_f32_32x32x16_bf16 v[32:47], v[116:119], v[192:195], v[32:47]
    ds_read_b64_tr_b16 v[108:109], v237 offset:2048
    ds_read_b64_tr_b16 v[110:111], v237 offset:2560
    s_waitcnt lgkmcnt(4)
    s_add_u32 s58, s49, s59
    s_add_u32 m0, s50, 0
    s_mul_i32 s58, s58, 57344
    buffer_load_dwordx4 v232, s[16:19], s58 offen  lds
    s_add_u32 m0, s50, 1024
    v_mfma_f32_32x32x16_bf16 v[48:63], v[116:119], v[196:199], v[48:63]
    s_nop 0
    buffer_load_dwordx4 v233, s[16:19], s58 offen  lds
    s_waitcnt vmcnt(18)
    v_mfma_f32_32x32x16_bf16 v[0:15], v[120:123], v[200:203], v[0:15]
    s_add_u32 s60, s9, s51
    s_lshl_b32 s60, s60, 11
    buffer_load_dwordx4 v[192:195], v234, s[20:23], s60 offen sc1
    buffer_load_dwordx4 v[196:199], v235, s[20:23], s60 offen sc1
    v_mfma_f32_32x32x16_bf16 v[16:31], v[120:123], v[204:207], v[16:31]
    ds_read_b64_tr_b16 v[112:113], v236 offset:4096
    ds_read_b64_tr_b16 v[114:115], v236 offset:4608
    v_mfma_f32_32x32x16_bf16 v[32:47], v[124:127], v[200:203], v[32:47]
    ds_read_b64_tr_b16 v[116:117], v237 offset:4096
    ds_read_b64_tr_b16 v[118:119], v237 offset:4608
    s_waitcnt lgkmcnt(4)
    s_add_u32 s58, s49, s3
    s_add_u32 m0, s50, 2048
    s_mul_i32 s58, s58, 57344
    buffer_load_dwordx4 v232, s[16:19], s58 offen  lds
    s_add_u32 m0, s50, 3072
    v_mfma_f32_32x32x16_bf16 v[48:63], v[124:127], v[204:207], v[48:63]
    s_nop 0
    buffer_load_dwordx4 v233, s[16:19], s58 offen  lds
    s_waitcnt vmcnt(18)
    v_mfma_f32_32x32x16_bf16 v[0:15], v[128:131], v[208:211], v[0:15]
    s_add_u32 s60, s9, s15
    s_lshl_b32 s60, s60, 11
    buffer_load_dwordx4 v[200:203], v234, s[20:23], s60 offen sc1
    v_mfma_f32_32x32x16_bf16 v[16:31], v[128:131], v[212:215], v[16:31]
    buffer_load_dwordx4 v[204:207], v235, s[20:23], s60 offen sc1
    v_mfma_f32_32x32x16_bf16 v[32:47], v[132:135], v[208:211], v[32:47]
    ds_read_b64_tr_b16 v[120:121], v236 offset:6144
    ds_read_b64_tr_b16 v[122:123], v236 offset:6656
    v_mfma_f32_32x32x16_bf16 v[48:63], v[132:135], v[212:215], v[48:63]
    ds_read_b64_tr_b16 v[124:125], v237 offset:6144
    ds_read_b64_tr_b16 v[126:127], v237 offset:6656
    s_waitcnt vmcnt(16)
    v_mfma_f32_32x32x16_bf16 v[0:15], v[136:139], v[216:219], v[0:15]
    s_add_u32 s60, s9, s59
    s_lshl_b32 s60, s60, 11
    buffer_load_dwordx4 v[208:211], v234, s[20:23], s60 offen sc1
    v_mfma_f32_32x32x16_bf16 v[16:31], v[136:139], v[220:223], v[16:31]
    buffer_load_dwordx4 v[212:215], v235, s[20:23], s60 offen sc1
    v_mfma_f32_32x32x16_bf16 v[32:47], v[140:143], v[216:219], v[32:47]
    ds_read_b64_tr_b16 v[128:129], v236 offset:8192
    ds_read_b64_tr_b16 v[130:131], v236 offset:8704
    v_mfma_f32_32x32x16_bf16 v[48:63], v[140:143], v[220:223], v[48:63]
    ds_read_b64_tr_b16 v[132:133], v237 offset:8192
    ds_read_b64_tr_b16 v[134:135], v237 offset:8704
    s_waitcnt vmcnt(14)
    v_mfma_f32_32x32x16_bf16 v[0:15], v[144:147], v[224:227], v[0:15]
    s_add_u32 s60, s9, s3
    s_lshl_b32 s60, s60, 11
    buffer_load_dwordx4 v[216:219], v234, s[20:23], s60 offen sc1
    v_mfma_f32_32x32x16_bf16 v[16:31], v[144:147], v[228:231], v[16:31]
    buffer_load_dwordx4 v[220:223], v235, s[20:23], s60 offen sc1
    v_mfma_f32_32x32x16_bf16 v[32:47], v[148:151], v[224:227], v[32:47]
    ds_read_b64_tr_b16 v[136:137], v236 offset:10240
    ds_read_b64_tr_b16 v[138:139], v236 offset:10752
    v_mfma_f32_32x32x16_bf16 v[48:63], v[148:151], v[228:231], v[48:63]
    ds_read_b64_tr_b16 v[140:141], v237 offset:10240
    ds_read_b64_tr_b16 v[142:143], v237 offset:10752
    s_waitcnt vmcnt(12)
    v_mfma_f32_32x32x16_bf16 v[0:15], v[152:155], v[240:243], v[0:15]
    s_add_u32 s60, s10, s51
    s_lshl_b32 s60, s60, 11
    buffer_load_dwordx4 v[224:227], v234, s[20:23], s60 offen sc1
    v_mfma_f32_32x32x16_bf16 v[16:31], v[152:155], v[244:247], v[16:31]
    buffer_load_dwordx4 v[228:231], v235, s[20:23], s60 offen sc1
    v_mfma_f32_32x32x16_bf16 v[32:47], v[156:159], v[240:243], v[32:47]
    ds_read_b64_tr_b16 v[144:145], v236 offset:12288
    ds_read_b64_tr_b16 v[146:147], v236 offset:12800
    v_mfma_f32_32x32x16_bf16 v[48:63], v[156:159], v[244:247], v[48:63]
    ds_read_b64_tr_b16 v[148:149], v237 offset:12288
    ds_read_b64_tr_b16 v[150:151], v237 offset:12800
    s_waitcnt vmcnt(10)
    v_mfma_f32_32x32x16_bf16 v[0:15], v[160:163], v[192:195], v[0:15]
    s_add_u32 s60, s10, s15
    s_lshl_b32 s60, s60, 11
    buffer_load_dwordx4 v[240:243], v234, s[20:23], s60 offen sc1
    v_mfma_f32_32x32x16_bf16 v[16:31], v[160:163], v[196:199], v[16:31]
    buffer_load_dwordx4 v[244:247], v235, s[20:23], s60 offen sc1
    v_mfma_f32_32x32x16_bf16 v[32:47], v[164:167], v[192:195], v[32:47]
    ds_read_b64_tr_b16 v[152:153], v236 offset:14336
    ds_read_b64_tr_b16 v[154:155], v236 offset:14848
    v_mfma_f32_32x32x16_bf16 v[48:63], v[164:167], v[196:199], v[48:63]
    ds_read_b64_tr_b16 v[156:157], v237 offset:14336
    ds_read_b64_tr_b16 v[158:159], v237 offset:14848
    s_waitcnt vmcnt(8)
    v_mfma_f32_32x32x16_bf16 v[0:15], v[168:171], v[200:203], v[0:15]
    s_add_u32 s60, s10, s59
    s_lshl_b32 s60, s60, 11
    buffer_load_dwordx4 v[192:195], v234, s[20:23], s60 offen sc1
    v_mfma_f32_32x32x16_bf16 v[16:31], v[168:171], v[204:207], v[16:31]
    buffer_load_dwordx4 v[196:199], v235, s[20:23], s60 offen sc1
    v_mfma_f32_32x32x16_bf16 v[32:47], v[172:175], v[200:203], v[32:47]
    ds_read_b64_tr_b16 v[160:161], v236 offset:16384
    ds_read_b64_tr_b16 v[162:163], v236 offset:16896
    v_mfma_f32_32x32x16_bf16 v[48:63], v[172:175], v[204:207], v[48:63]
    ds_read_b64_tr_b16 v[164:165], v237 offset:16384
    ds_read_b64_tr_b16 v[166:167], v237 offset:16896
    s_waitcnt vmcnt(8)
    v_mfma_f32_32x32x16_bf16 v[0:15], v[176:179], v[208:211], v[0:15]
    s_add_u32 s60, s10, s3
    s_lshl_b32 s60, s60, 11
    buffer_load_dwordx4 v[200:203], v234, s[20:23], s60 offen sc1
    v_mfma_f32_32x32x16_bf16 v[16:31], v[176:179], v[212:215], v[16:31]
    buffer_load_dwordx4 v[204:207], v235, s[20:23], s60 offen sc1
    v_mfma_f32_32x32x16_bf16 v[32:47], v[180:183], v[208:211], v[32:47]
    ds_read_b64_tr_b16 v[168:169], v236 offset:18432
    ds_read_b64_tr_b16 v[170:171], v236 offset:18944
    v_mfma_f32_32x32x16_bf16 v[48:63], v[180:183], v[212:215], v[48:63]
    ds_read_b64_tr_b16 v[172:173], v237 offset:18432
    ds_read_b64_tr_b16 v[174:175], v237 offset:18944
    s_waitcnt vmcnt(8)
    v_mfma_f32_32x32x16_bf16 v[0:15], v[184:187], v[216:219], v[0:15]
    s_add_u32 s60, s11, s51
    s_lshl_b32 s60, s60, 11
    buffer_load_dwordx4 v[208:211], v234, s[20:23], s60 offen sc1
    v_mfma_f32_32x32x16_bf16 v[16:31], v[184:187], v[220:223], v[16:31]
    buffer_load_dwordx4 v[212:215], v235, s[20:23], s60 offen sc1
    v_mfma_f32_32x32x16_bf16 v[32:47], v[188:191], v[216:219], v[32:47]
    ds_read_b64_tr_b16 v[176:177], v236 offset:0
    ds_read_b64_tr_b16 v[178:179], v236 offset:512
    v_mfma_f32_32x32x16_bf16 v[48:63], v[188:191], v[220:223], v[48:63]
    ds_read_b64_tr_b16 v[180:181], v237 offset:0
    ds_read_b64_tr_b16 v[182:183], v237 offset:512
    s_waitcnt vmcnt(8)
    v_mfma_f32_32x32x16_bf16 v[0:15], v[64:67], v[224:227], v[0:15]
    s_add_u32 s60, s11, s15
    s_lshl_b32 s60, s60, 11
    buffer_load_dwordx4 v[216:219], v234, s[20:23], s60 offen sc1
    buffer_load_dwordx4 v[220:223], v235, s[20:23], s60 offen sc1
    v_mfma_f32_32x32x16_bf16 v[16:31], v[64:67], v[228:231], v[16:31]
    ds_read_b64_tr_b16 v[184:185], v236 offset:2048
    ds_read_b64_tr_b16 v[186:187], v236 offset:2560
    v_mfma_f32_32x32x16_bf16 v[32:47], v[68:71], v[224:227], v[32:47]
    ds_read_b64_tr_b16 v[188:189], v237 offset:2048
    ds_read_b64_tr_b16 v[190:191], v237 offset:2560
    v_mfma_f32_32x32x16_bf16 v[48:63], v[68:71], v[228:231], v[48:63]
    s_lshl_b32 s69, s56, 8
    s_add_u32 s69, s69, 0x843800
    buffer_load_dword v251, v250, s[32:35], s69 offen sc1
    s_waitcnt vmcnt(9)
    v_mfma_f32_32x32x16_bf16 v[0:15], v[72:75], v[240:243], v[0:15]
    s_add_u32 s60, s11, s59
    s_lshl_b32 s60, s60, 11
    buffer_load_dwordx4 v[64:67], v234, s[20:23], s60 offen sc1
    buffer_load_dwordx4 v[68:71], v235, s[20:23], s60 offen sc1
    v_mfma_f32_32x32x16_bf16 v[16:31], v[72:75], v[244:247], v[16:31]
    s_add_u32 s60, s11, s3
    s_lshl_b32 s60, s60, 11
    buffer_load_dwordx4 v[224:227], v234, s[20:23], s60 offen sc1
    v_mfma_f32_32x32x16_bf16 v[32:47], v[76:79], v[240:243], v[32:47]
    buffer_load_dwordx4 v[228:231], v235, s[20:23], s60 offen sc1
    v_mfma_f32_32x32x16_bf16 v[48:63], v[76:79], v[244:247], v[48:63]
    s_waitcnt lgkmcnt(0)
    v_lshrrev_b32 v252, 3, v238
    v_mul_u32_u24 v232, 4096, v252
    v_lshrrev_b32 v253, 2, v238
    v_and_b32 v253, 4, v253
    v_and_b32 v254, 7, v238
    v_xor_b32 v253, v253, v254
    v_lshl_add_u32 v232, v253, 4, v232
    v_add_u32 v232, s67, v232
    v_add_u32 v233, 32768, v232
    v_bfe_u32 v252, v238, 4, 1
    v_lshrrev_b32 v253, 5, v238
    v_lshlrev_b32 v236, 9, v253
    v_lshl_add_u32 v236, v252, 5, v236
    v_bfe_u32 v253, v238, 2, 2
    v_lshl_add_u32 v236, v253, 7, v236
    v_lshrrev_b32 v253, 1, v253
    v_lshl_add_u32 v236, v253, 6, v236
    v_and_b32 v253, 3, v238
    v_lshl_add_u32 v236, v253, 3, v236
    s_lshl_b32 s36, s14, 5
    s_and_b32 s36, s36, 64
    v_xor_b32 v236, s36, v236
    v_add_u32 v236, s50, v236
    v_xor_b32 v237, 64, v236
    s_waitcnt vmcnt(11)
    v_mfma_f32_32x32x16_bf16 v[0:15], v[80:83], v[192:195], v[0:15]
    s_add_u32 s60, s48, s51
    s_lshl_b32 s60, s60, 11
    buffer_load_dwordx4 v[72:75], v234, s[20:23], s60 offen sc1
    v_mfma_f32_32x32x16_bf16 v[16:31], v[80:83], v[196:199], v[16:31]
    buffer_load_dwordx4 v[76:79], v235, s[20:23], s60 offen sc1
    v_mfma_f32_32x32x16_bf16 v[32:47], v[84:87], v[192:195], v[32:47]
    s_add_u32 s60, s48, s15
    s_lshl_b32 s60, s60, 11
    buffer_load_dwordx4 v[240:243], v234, s[20:23], s60 offen sc1
    v_mfma_f32_32x32x16_bf16 v[48:63], v[84:87], v[196:199], v[48:63]
    buffer_load_dwordx4 v[244:247], v235, s[20:23], s60 offen sc1
    s_waitcnt vmcnt(13)
    v_mfma_f32_32x32x16_bf16 v[0:15], v[88:91], v[200:203], v[0:15]
    s_add_u32 s60, s48, s59
    s_lshl_b32 s60, s60, 11
    buffer_load_dwordx4 v[80:83], v234, s[20:23], s60 offen sc1
    v_mfma_f32_32x32x16_bf16 v[16:31], v[88:91], v[204:207], v[16:31]
    buffer_load_dwordx4 v[84:87], v235, s[20:23], s60 offen sc1
    v_mfma_f32_32x32x16_bf16 v[32:47], v[92:95], v[200:203], v[32:47]
    v_mfma_f32_32x32x16_bf16 v[48:63], v[92:95], v[204:207], v[48:63]
    s_waitcnt vmcnt(13)
    v_mfma_f32_32x32x16_bf16 v[0:15], v[96:99], v[208:211], v[0:15]
    s_add_u32 s60, s48, s3
    s_lshl_b32 s60, s60, 11
    buffer_load_dwordx4 v[88:91], v234, s[20:23], s60 offen sc1
    v_mfma_f32_32x32x16_bf16 v[16:31], v[96:99], v[212:215], v[16:31]
    buffer_load_dwordx4 v[92:95], v235, s[20:23], s60 offen sc1
    v_mfma_f32_32x32x16_bf16 v[32:47], v[100:103], v[208:211], v[32:47]
    v_mfma_f32_32x32x16_bf16 v[48:63], v[100:103], v[212:215], v[48:63]
    s_waitcnt vmcnt(13)
    v_mfma_f32_32x32x16_bf16 v[0:15], v[104:107], v[216:219], v[0:15]
    s_add_u32 s60, s49, s51
    s_lshl_b32 s60, s60, 11
    buffer_load_dwordx4 v[96:99], v234, s[20:23], s60 offen sc1
    v_mfma_f32_32x32x16_bf16 v[16:31], v[104:107], v[220:223], v[16:31]
    buffer_load_dwordx4 v[100:103], v235, s[20:23], s60 offen sc1
    v_mfma_f32_32x32x16_bf16 v[32:47], v[108:111], v[216:219], v[32:47]
    v_mfma_f32_32x32x16_bf16 v[48:63], v[108:111], v[220:223], v[48:63]
    s_waitcnt vmcnt(14)
    v_readfirstlane_b32 s61, v251
    s_cmp_lg_u32 s61, 0
    s_cbranch_scc1 FLAG_19
    s_mov_b32 s60, 0
    s_mov_b64 exec, 1
POLL_20:
    buffer_load_dword v251, v250, s[32:35], s69 offen sc1
    s_add_u32 s60, s60, 1
    s_waitcnt vmcnt(0)
    v_readfirstlane_b32 s61, v251
    s_cmp_ge_u32 s61, 1
    s_cbranch_scc1 POLLD_21
    s_sleep 2
    s_cmp_lt_u32 s60, 0x40000
    s_cbranch_scc1 POLL_20
POLLD_21:
    s_mov_b64 exec, -1
FLAG_19:
    s_waitcnt vmcnt(12)
    v_mfma_f32_32x32x16_bf16 v[0:15], v[112:115], v[64:67], v[0:15]
    s_add_u32 s60, s49, s15
    s_lshl_b32 s60, s60, 11
    buffer_load_dwordx4 v[104:107], v234, s[20:23], s60 offen sc1
    v_mfma_f32_32x32x16_bf16 v[16:31], v[112:115], v[68:71], v[16:31]
    buffer_load_dwordx4 v[108:111], v235, s[20:23], s60 offen sc1
    v_mfma_f32_32x32x16_bf16 v[32:47], v[116:119], v[64:67], v[32:47]
    v_mfma_f32_32x32x16_bf16 v[48:63], v[116:119], v[68:71], v[48:63]
    s_waitcnt vmcnt(12)
    v_mfma_f32_32x32x16_bf16 v[0:15], v[120:123], v[224:227], v[0:15]
    s_add_u32 s60, s49, s59
    s_lshl_b32 s60, s60, 11
    buffer_load_dwordx4 v[112:115], v234, s[20:23], s60 offen sc1
    v_mfma_f32_32x32x16_bf16 v[16:31], v[120:123], v[228:231], v[16:31]
    buffer_load_dwordx4 v[116:119], v235, s[20:23], s60 offen sc1
    v_mfma_f32_32x32x16_bf16 v[32:47], v[124:127], v[224:227], v[32:47]
    v_mfma_f32_32x32x16_bf16 v[48:63], v[124:127], v[228:231], v[48:63]
    s_waitcnt vmcnt(12)
    v_mfma_f32_32x32x16_bf16 v[0:15], v[128:131], v[72:75], v[0:15]
    s_add_u32 s60, s49, s3
    s_lshl_b32 s60, s60, 11
    buffer_load_dwordx4 v[120:123], v234, s[20:23], s60 offen sc1
    v_mfma_f32_32x32x16_bf16 v[16:31], v[128:131], v[76:79], v[16:31]
    buffer_load_dwordx4 v[124:127], v235, s[20:23], s60 offen sc1
    v_mfma_f32_32x32x16_bf16 v[32:47], v[132:135], v[72:75], v[32:47]
    v_mfma_f32_32x32x16_bf16 v[48:63], v[132:135], v[76:79], v[48:63]
    s_waitcnt vmcnt(12)
    v_mfma_f32_32x32x16_bf16 v[0:15], v[136:139], v[240:243], v[0:15]
    v_mfma_f32_32x32x16_bf16 v[16:31], v[136:139], v[244:247], v[16:31]
    v_mfma_f32_32x32x16_bf16 v[32:47], v[140:143], v[240:243], v[32:47]
    v_mfma_f32_32x32x16_bf16 v[48:63], v[140:143], v[244:247], v[48:63]
    s_waitcnt vmcnt(10)
    v_mfma_f32_32x32x16_bf16 v[0:15], v[144:147], v[80:83], v[0:15]
    v_mfma_f32_32x32x16_bf16 v[16:31], v[144:147], v[84:87], v[16:31]
    v_mfma_f32_32x32x16_bf16 v[32:47], v[148:151], v[80:83], v[32:47]
    v_mfma_f32_32x32x16_bf16 v[48:63], v[148:151], v[84:87], v[48:63]
    s_waitcnt vmcnt(8)
    v_mfma_f32_32x32x16_bf16 v[0:15], v[152:155], v[88:91], v[0:15]
    v_mfma_f32_32x32x16_bf16 v[16:31], v[152:155], v[92:95], v[16:31]
    v_mfma_f32_32x32x16_bf16 v[32:47], v[156:159], v[88:91], v[32:47]
    v_mfma_f32_32x32x16_bf16 v[48:63], v[156:159], v[92:95], v[48:63]
    s_waitcnt vmcnt(6)
    v_mfma_f32_32x32x16_bf16 v[0:15], v[160:163], v[96:99], v[0:15]
    v_mfma_f32_32x32x16_bf16 v[16:31], v[160:163], v[100:103], v[16:31]
    v_mfma_f32_32x32x16_bf16 v[32:47], v[164:167], v[96:99], v[32:47]
    v_mfma_f32_32x32x16_bf16 v[48:63], v[164:167], v[100:103], v[48:63]
    s_waitcnt vmcnt(4)
    s_waitcnt vmcnt(2)
    s_waitcnt vmcnt(0)
    s_lshl_b32 s56, s14, 14
    s_add_u32 s56, s56, 229376
    v_add_u32 v251, s50, v239
    v_mfma_f32_32x32x16_bf16 v[16:31], v[168:171], v[108:111], v[16:31]
    v_mfma_f32_32x32x16_bf16 v[16:31], v[176:179], v[116:119], v[16:31]
    v_mfma_f32_32x32x16_bf16 v[16:31], v[184:187], v[124:127], v[16:31]
    v_mfma_f32_32x32x16_bf16 v[32:47], v[172:175], v[104:107], v[32:47]
    s_nop 10
    ds_write_b128 v251, v[16:19] offset:8192
    v_mfma_f32_32x32x16_bf16 v[32:47], v[180:183], v[112:115], v[32:47]
    ds_write_b128 v251, v[20:23] offset:9216
    ds_write_b128 v251, v[24:27] offset:10240
    v_mfma_f32_32x32x16_bf16 v[32:47], v[188:191], v[120:123], v[32:47]
    ds_write_b128 v251, v[28:31] offset:11264
    v_mfma_f32_32x32x16_bf16 v[48:63], v[172:175], v[108:111], v[48:63]
    s_nop 10
    ds_write_b128 v251, v[32:35] offset:12288
    v_mfma_f32_32x32x16_bf16 v[48:63], v[180:183], v[116:119], v[48:63]
    ds_write_b128 v251, v[36:39] offset:13312
    ds_write_b128 v251, v[40:43] offset:14336
    v_mfma_f32_32x32x16_bf16 v[48:63], v[188:191], v[124:127], v[48:63]
    ds_write_b128 v251, v[44:47] offset:15360
    v_mfma_f32_32x32x16_bf16 v[0:15], v[168:171], v[104:107], v[0:15]
    s_nop 10
    ds_write_b128 v251, v[48:51] offset:16384
    v_mfma_f32_32x32x16_bf16 v[0:15], v[176:179], v[112:115], v[0:15]
    ds_write_b128 v251, v[52:55] offset:17408
    ds_write_b128 v251, v[56:59] offset:18432
    v_mfma_f32_32x32x16_bf16 v[0:15], v[184:187], v[120:123], v[0:15]
    ds_write_b128 v251, v[60:63] offset:19456
    s_xor_b32 s60, s14, 1
    s_mul_i32 s60, s60, 20480
    v_add_u32 v252, s60, v239
    s_xor_b32 s60, s14, 2
    s_mul_i32 s60, s60, 20480
    v_add_u32 v253, s60, v239
    s_xor_b32 s60, s14, 3
    s_mul_i32 s60, s60, 20480
    v_add_u32 v254, s60, v239
    s_add_u32 s58, s6, s51
    s_add_u32 m0, s50, 0
    s_mul_i32 s58, s58, 65536
    buffer_load_dwordx4 v232, s[24:27], s58 offen  lds
    s_add_u32 m0, s50, 1024
    s_nop 0
    buffer_load_dwordx4 v233, s[24:27], s58 offen  lds
    s_add_u32 s58, s6, s15
    s_add_u32 m0, s50, 2048
    s_mul_i32 s58, s58, 65536
    buffer_load_dwordx4 v232, s[24:27], s58 offen  lds
    s_add_u32 m0, s50, 3072
    s_nop 0
    buffer_load_dwordx4 v233, s[24:27], s58 offen  lds
    s_add_u32 s58, s6, s59
    s_add_u32 m0, s50, 4096
    s_mul_i32 s58, s58, 65536
    buffer_load_dwordx4 v232, s[24:27], s58 offen  lds
    s_add_u32 m0, s50, 5120
    s_nop 0
    buffer_load_dwordx4 v233, s[24:27], s58 offen  lds
    s_add_u32 s58, s6, s3
    s_add_u32 m0, s50, 6144
    s_mul_i32 s58, s58, 65536
    buffer_load_dwordx4 v232, s[24:27], s58 offen  lds
    s_add_u32 m0, s50, 7168
    s_nop 0
    buffer_load_dwordx4 v233, s[24:27], s58 offen  lds
    s_waitcnt lgkmcnt(0)
    s_barrier
    ds_read_b128 v[16:19], v252 offset:8192
    ds_read_b128 v[20:23], v252 offset:9216
    ds_read_b128 v[24:27], v252 offset:10240
    ds_read_b128 v[28:31], v252 offset:11264
    ds_read_b128 v[32:35], v253 offset:12288
    ds_read_b128 v[36:39], v253 offset:13312
    ds_read_b128 v[40:43], v253 offset:14336
    ds_read_b128 v[44:47], v253 offset:15360
    ds_read_b128 v[48:51], v254 offset:16384
    ds_read_b128 v[52:55], v254 offset:17408
    ds_read_b128 v[56:59], v254 offset:18432
    ds_read_b128 v[60:63], v254 offset:19456
    s_waitcnt lgkmcnt(8)
    v_pk_add_f32 v[0:1], v[0:1], v[16:17]
    v_pk_add_f32 v[2:3], v[2:3], v[18:19]
    v_pk_add_f32 v[4:5], v[4:5], v[20:21]
    v_pk_add_f32 v[6:7], v[6:7], v[22:23]
    v_pk_add_f32 v[8:9], v[8:9], v[24:25]
    v_pk_add_f32 v[10:11], v[10:11], v[26:27]
    v_pk_add_f32 v[12:13], v[12:13], v[28:29]
    v_pk_add_f32 v[14:15], v[14:15], v[30:31]
    s_waitcnt lgkmcnt(4)
    v_pk_add_f32 v[0:1], v[0:1], v[32:33]
    v_pk_add_f32 v[2:3], v[2:3], v[34:35]
    v_pk_add_f32 v[4:5], v[4:5], v[36:37]
    v_pk_add_f32 v[6:7], v[6:7], v[38:39]
    v_pk_add_f32 v[8:9], v[8:9], v[40:41]
    v_pk_add_f32 v[10:11], v[10:11], v[42:43]
    v_pk_add_f32 v[12:13], v[12:13], v[44:45]
    v_pk_add_f32 v[14:15], v[14:15], v[46:47]
    s_waitcnt lgkmcnt(0)
    v_pk_add_f32 v[0:1], v[0:1], v[48:49]
    v_pk_add_f32 v[2:3], v[2:3], v[50:51]
    v_pk_add_f32 v[4:5], v[4:5], v[52:53]
    v_pk_add_f32 v[6:7], v[6:7], v[54:55]
    v_pk_add_f32 v[8:9], v[8:9], v[56:57]
    v_pk_add_f32 v[10:11], v[10:11], v[58:59]
    v_pk_add_f32 v[12:13], v[12:13], v[60:61]
    v_pk_add_f32 v[14:15], v[14:15], v[62:63]
    s_barrier
    s_mov_b32 s60, 0xbdd2d3e8
    v_mov_b32 v48, 0xc0135761
    s_add_u32 s58, s7, s51
    s_add_u32 m0, s50, 8192
    s_mul_i32 s58, s58, 65536
    buffer_load_dwordx4 v232, s[24:27], s58 offen  lds
    s_add_u32 m0, s50, 9216
    s_nop 0
    buffer_load_dwordx4 v233, s[24:27], s58 offen  lds
    v_pk_mul_f32 v[16:17], v[0:1], v[0:1]
    v_pk_mul_f32 v[18:19], v[2:3], v[2:3]
    v_pk_mul_f32 v[20:21], v[4:5], v[4:5]
    v_pk_mul_f32 v[22:23], v[6:7], v[6:7]
    v_pk_mul_f32 v[24:25], v[8:9], v[8:9]
    v_pk_mul_f32 v[26:27], v[10:11], v[10:11]
    v_pk_mul_f32 v[28:29], v[12:13], v[12:13]
    v_pk_mul_f32 v[30:31], v[14:15], v[14:15]
    s_add_u32 s58, s7, s15
    s_add_u32 m0, s50, 10240
    s_mul_i32 s58, s58, 65536
    buffer_load_dwordx4 v232, s[24:27], s58 offen  lds
    s_add_u32 m0, s50, 11264
    s_nop 0
    buffer_load_dwordx4 v233, s[24:27], s58 offen  lds
    v_fma_f32 v16, v16, s60, v48
    v_fma_f32 v17, v17, s60, v48
    v_fma_f32 v18, v18, s60, v48
    v_fma_f32 v19, v19, s60, v48
    v_fma_f32 v20, v20, s60, v48
    v_fma_f32 v21, v21, s60, v48
    v_fma_f32 v22, v22, s60, v48
    v_fma_f32 v23, v23, s60, v48
    v_fma_f32 v24, v24, s60, v48
    v_fma_f32 v25, v25, s60, v48
    v_fma_f32 v26, v26, s60, v48
    v_fma_f32 v27, v27, s60, v48
    v_fma_f32 v28, v28, s60, v48
    v_fma_f32 v29, v29, s60, v48
    v_fma_f32 v30, v30, s60, v48
    v_fma_f32 v31, v31, s60, v48
    s_add_u32 s58, s7, s59
    s_add_u32 m0, s50, 12288
    s_mul_i32 s58, s58, 65536
    buffer_load_dwordx4 v232, s[24:27], s58 offen  lds
    s_add_u32 m0, s50, 13312
    s_nop 0
    buffer_load_dwordx4 v233, s[24:27], s58 offen  lds
    v_pk_mul_f32 v[16:17], v[16:17], v[0:1]
    v_pk_mul_f32 v[18:19], v[18:19], v[2:3]
    v_pk_mul_f32 v[20:21], v[20:21], v[4:5]
    v_pk_mul_f32 v[22:23], v[22:23], v[6:7]
    v_pk_mul_f32 v[24:25], v[24:25], v[8:9]
    v_pk_mul_f32 v[26:27], v[26:27], v[10:11]
    v_pk_mul_f32 v[28:29], v[28:29], v[12:13]
    v_pk_mul_f32 v[30:31], v[30:31], v[14:15]
    v_exp_f32 v16, v16
    v_exp_f32 v17, v17
    v_exp_f32 v18, v18
    v_exp_f32 v19, v19
    v_exp_f32 v20, v20
    v_exp_f32 v21, v21
    v_exp_f32 v22, v22
    v_exp_f32 v23, v23
    v_exp_f32 v24, v24
    v_exp_f32 v25, v25
    v_exp_f32 v26, v26
    v_exp_f32 v27, v27
    v_exp_f32 v28, v28
    v_exp_f32 v29, v29
    v_exp_f32 v30, v30
    v_exp_f32 v31, v31
    v_add_f32 v16, 1.0, v16
    v_add_f32 v17, 1.0, v17
    v_add_f32 v18, 1.0, v18
    v_add_f32 v19, 1.0, v19
    v_add_f32 v20, 1.0, v20
    v_add_f32 v21, 1.0, v21
    v_add_f32 v22, 1.0, v22
    v_add_f32 v23, 1.0, v23
    v_add_f32 v24, 1.0, v24
    v_add_f32 v25, 1.0, v25
    v_add_f32 v26, 1.0, v26
    v_add_f32 v27, 1.0, v27
    v_add_f32 v28, 1.0, v28
    v_add_f32 v29, 1.0, v29
    v_add_f32 v30, 1.0, v30
    v_add_f32 v31, 1.0, v31
    v_rcp_f32 v16, v16
    v_rcp_f32 v17, v17
    v_rcp_f32 v18, v18
    v_rcp_f32 v19, v19
    v_rcp_f32 v20, v20
    v_rcp_f32 v21, v21
    v_rcp_f32 v22, v22
    v_rcp_f32 v23, v23
    v_rcp_f32 v24, v24
    v_rcp_f32 v25, v25
    v_rcp_f32 v26, v26
    v_rcp_f32 v27, v27
    v_rcp_f32 v28, v28
    v_rcp_f32 v29, v29
    v_rcp_f32 v30, v30
    v_rcp_f32 v31, v31
    s_lshl_b32 s60, s66, 2
    s_and_b32 s61, s14, 2
    s_add_u32 s60, s60, s61
    s_lshl_b32 s60, s60, 11
    v_pk_mul_f32 v[0:1], v[0:1], v[16:17]
    v_pk_mul_f32 v[2:3], v[2:3], v[18:19]
    v_pk_mul_f32 v[4:5], v[4:5], v[20:21]
    v_pk_mul_f32 v[6:7], v[6:7], v[22:23]
    v_cvt_pk_bf16_f32 v32, v0, v1
    v_cvt_pk_bf16_f32 v33, v2, v3
    v_cvt_pk_bf16_f32 v34, v4, v5
    v_cvt_pk_bf16_f32 v35, v6, v7
    buffer_store_dwordx4 v[32:35], v234, s[40:43], s60 offen offset:0 sc1
    v_pk_mul_f32 v[8:9], v[8:9], v[24:25]
    v_pk_mul_f32 v[10:11], v[10:11], v[26:27]
    v_pk_mul_f32 v[12:13], v[12:13], v[28:29]
    v_pk_mul_f32 v[14:15], v[14:15], v[30:31]
    v_cvt_pk_bf16_f32 v36, v8, v9
    v_cvt_pk_bf16_f32 v37, v10, v11
    v_cvt_pk_bf16_f32 v38, v12, v13
    v_cvt_pk_bf16_f32 v39, v14, v15
    buffer_store_dwordx4 v[36:39], v234, s[40:43], s60 offen offset:2048 sc1
    s_add_u32 s58, s7, s3
    s_add_u32 m0, s50, 14336
    s_mul_i32 s58, s58, 65536
    buffer_load_dwordx4 v232, s[24:27], s58 offen  lds
    s_add_u32 m0, s50, 15360
    s_nop 0
    buffer_load_dwordx4 v233, s[24:27], s58 offen  lds
    s_add_u32 s58, s8, s51
    s_add_u32 m0, s50, 16384
    s_mul_i32 s58, s58, 65536
    buffer_load_dwordx4 v232, s[24:27], s58 offen  lds
    s_add_u32 m0, s50, 17408
    s_nop 0
    buffer_load_dwordx4 v233, s[24:27], s58 offen  lds
    s_add_u32 s58, s8, s15
    s_add_u32 m0, s50, 18432
    s_mul_i32 s58, s58, 65536
    buffer_load_dwordx4 v232, s[24:27], s58 offen  lds
    s_add_u32 m0, s50, 19456
    s_nop 0
    buffer_load_dwordx4 v233, s[24:27], s58 offen  lds
    s_waitcnt vmcnt(20)
    ds_read_b64_tr_b16 v[64:65], v236 offset:0
    ds_read_b64_tr_b16 v[66:67], v236 offset:1024
    ds_read_b64_tr_b16 v[68:69], v237 offset:0
    ds_read_b64_tr_b16 v[70:71], v237 offset:1024
    s_waitcnt vmcnt(18)
    ds_read_b64_tr_b16 v[72:73], v236 offset:2048
    ds_read_b64_tr_b16 v[74:75], v236 offset:3072
    ds_read_b64_tr_b16 v[76:77], v237 offset:2048
    ds_read_b64_tr_b16 v[78:79], v237 offset:3072
    s_waitcnt vmcnt(16)
    ds_read_b64_tr_b16 v[80:81], v236 offset:4096
    ds_read_b64_tr_b16 v[82:83], v236 offset:5120
    ds_read_b64_tr_b16 v[84:85], v237 offset:4096
    ds_read_b64_tr_b16 v[86:87], v237 offset:5120
    s_waitcnt vmcnt(14)
    ds_read_b64_tr_b16 v[88:89], v236 offset:6144
    ds_read_b64_tr_b16 v[90:91], v236 offset:7168
    ds_read_b64_tr_b16 v[92:93], v237 offset:6144
    ds_read_b64_tr_b16 v[94:95], v237 offset:7168
    s_waitcnt vmcnt(12)
    ds_read_b64_tr_b16 v[96:97], v236 offset:8192
    ds_read_b64_tr_b16 v[98:99], v236 offset:9216
    ds_read_b64_tr_b16 v[100:101], v237 offset:8192
    ds_read_b64_tr_b16 v[102:103], v237 offset:9216
    s_waitcnt vmcnt(10)
    ds_read_b64_tr_b16 v[104:105], v236 offset:10240
    ds_read_b64_tr_b16 v[106:107], v236 offset:11264
    ds_read_b64_tr_b16 v[108:109], v237 offset:10240
    ds_read_b64_tr_b16 v[110:111], v237 offset:11264
    s_waitcnt vmcnt(8)
    ds_read_b64_tr_b16 v[112:113], v236 offset:12288
    ds_read_b64_tr_b16 v[114:115], v236 offset:13312
    ds_read_b64_tr_b16 v[116:117], v237 offset:12288
    ds_read_b64_tr_b16 v[118:119], v237 offset:13312
    s_waitcnt vmcnt(6)
    s_mov_b32 s65, s14
    s_branch G_JOIN2
G_JOIN:
    s_lshl_b32 s56, s14, 14
    s_add_u32 s56, s56, 229376
    s_add_u32 s58, s6, s51
    s_add_u32 m0, s50, 0
    s_mul_i32 s58, s58, 65536
    buffer_load_dwordx4 v232, s[24:27], s58 offen  lds
    s_add_u32 m0, s50, 1024
    s_nop 0
    buffer_load_dwordx4 v233, s[24:27], s58 offen  lds
    s_add_u32 s58, s6, s15
    s_add_u32 m0, s50, 2048
    s_mul_i32 s58, s58, 65536
    buffer_load_dwordx4 v232, s[24:27], s58 offen  lds
    s_add_u32 m0, s50, 3072
    s_nop 0
    buffer_load_dwordx4 v233, s[24:27], s58 offen  lds
    s_add_u32 s58, s6, s59
    s_add_u32 m0, s50, 4096
    s_mul_i32 s58, s58, 65536
    buffer_load_dwordx4 v232, s[24:27], s58 offen  lds
    s_add_u32 m0, s50, 5120
    s_nop 0
    buffer_load_dwordx4 v233, s[24:27], s58 offen  lds
    s_add_u32 s58, s6, s3
    s_add_u32 m0, s50, 6144
    s_mul_i32 s58, s58, 65536
    buffer_load_dwordx4 v232, s[24:27], s58 offen  lds
    s_add_u32 m0, s50, 7168
    s_nop 0
    buffer_load_dwordx4 v233, s[24:27], s58 offen  lds
    s_add_u32 s58, s7, s51
    s_add_u32 m0, s50, 8192
    s_mul_i32 s58, s58, 65536
    buffer_load_dwordx4 v232, s[24:27], s58 offen  lds
    s_add_u32 m0, s50, 9216
    s_nop 0
    buffer_load_dwordx4 v233, s[24:27], s58 offen  lds
    s_add_u32 s58, s7, s15
    s_add_u32 m0, s50, 10240
    s_mul_i32 s58, s58, 65536
    buffer_load_dwordx4 v232, s[24:27], s58 offen  lds
    s_add_u32 m0, s50, 11264
    s_nop 0
    buffer_load_dwordx4 v233, s[24:27], s58 offen  lds
    s_add_u32 s58, s7, s59
    s_add_u32 m0, s50, 12288
    s_mul_i32 s58, s58, 65536
    buffer_load_dwordx4 v232, s[24:27], s58 offen  lds
    s_add_u32 m0, s50, 13312
    s_nop 0
    buffer_load_dwordx4 v233, s[24:27], s58 offen  lds
    s_add_u32 s58, s7, s3
    s_add_u32 m0, s50, 14336
    s_mul_i32 s58, s58, 65536
    buffer_load_dwordx4 v232, s[24:27], s58 offen  lds
    s_add_u32 m0, s50, 15360
    s_nop 0
    buffer_load_dwordx4 v233, s[24:27], s58 offen  lds
    s_add_u32 s58, s8, s51
    s_add_u32 m0, s50, 16384
    s_mul_i32 s58, s58, 65536
    buffer_load_dwordx4 v232, s[24:27], s58 offen  lds
    s_add_u32 m0, s50, 17408
    s_nop 0
    buffer_load_dwordx4 v233, s[24:27], s58 offen  lds
    s_add_u32 s58, s8, s15
    s_add_u32 m0, s50, 18432
    s_mul_i32 s58, s58, 65536
    buffer_load_dwordx4 v232, s[24:27], s58 offen  lds
    s_add_u32 m0, s50, 19456
    s_nop 0
    buffer_load_dwordx4 v233, s[24:27], s58 offen  lds
    s_waitcnt vmcnt(18)
    ds_read_b64_tr_b16 v[64:65], v236 offset:0
    ds_read_b64_tr_b16 v[66:67], v236 offset:1024
    ds_read_b64_tr_b16 v[68:69], v237 offset:0
    ds_read_b64_tr_b16 v[70:71], v237 offset:1024
    s_waitcnt vmcnt(16)
    ds_read_b64_tr_b16 v[72:73], v236 offset:2048
    ds_read_b64_tr_b16 v[74:75], v236 offset:3072
    ds_read_b64_tr_b16 v[76:77], v237 offset:2048
    ds_read_b64_tr_b16 v[78:79], v237 offset:3072
    s_waitcnt vmcnt(14)
    ds_read_b64_tr_b16 v[80:81], v236 offset:4096
    ds_read_b64_tr_b16 v[82:83], v236 offset:5120
    ds_read_b64_tr_b16 v[84:85], v237 offset:4096
    ds_read_b64_tr_b16 v[86:87], v237 offset:5120
    s_waitcnt vmcnt(12)
    ds_read_b64_tr_b16 v[88:89], v236 offset:6144
    ds_read_b64_tr_b16 v[90:91], v236 offset:7168
    ds_read_b64_tr_b16 v[92:93], v237 offset:6144
    ds_read_b64_tr_b16 v[94:95], v237 offset:7168
    s_waitcnt vmcnt(10)
    ds_read_b64_tr_b16 v[96:97], v236 offset:8192
    ds_read_b64_tr_b16 v[98:99], v236 offset:9216
    ds_read_b64_tr_b16 v[100:101], v237 offset:8192
    ds_read_b64_tr_b16 v[102:103], v237 offset:9216
    s_waitcnt vmcnt(8)
    ds_read_b64_tr_b16 v[104:105], v236 offset:10240
    ds_read_b64_tr_b16 v[106:107], v236 offset:11264
    ds_read_b64_tr_b16 v[108:109], v237 offset:10240
    ds_read_b64_tr_b16 v[110:111], v237 offset:11264
    s_waitcnt vmcnt(6)
    ds_read_b64_tr_b16 v[112:113], v236 offset:12288
    ds_read_b64_tr_b16 v[114:115], v236 offset:13312
    ds_read_b64_tr_b16 v[116:117], v237 offset:12288
    ds_read_b64_tr_b16 v[118:119], v237 offset:13312
    s_waitcnt vmcnt(0) lgkmcnt(0)
G_JOIN2:
    s_barrier
    s_lshl_b32 s69, s64, 13
    s_add_u32 s69, s69, 0x850000
    s_cmp_lg_u32 s65, 0
    s_cbranch_scc1 G_NOARR
    s_lshl_b32 s61, s66, 8
    s_add_u32 s61, s61, s69
    s_mov_b32 s62, 1
    s_atomic_add s62, s[30:31], s61
G_NOARR:
    v_lshlrev_b32 v252, 8, v238
    s_waitcnt lgkmcnt(15)
    s_add_u32 s58, s8, s59
    s_add_u32 m0, s50, 0
    s_mul_i32 s58, s58, 65536
    buffer_load_dwordx4 v232, s[24:27], s58 offen  lds
    s_add_u32 m0, s50, 1024
    s_nop 0
    buffer_load_dwordx4 v233, s[24:27], s58 offen  lds
    s_add_u32 s58, s8, s3
    s_add_u32 m0, s50, 2048
    s_mul_i32 s58, s58, 65536
    buffer_load_dwordx4 v232, s[24:27], s58 offen  lds
    s_add_u32 m0, s50, 3072
    s_nop 0
    buffer_load_dwordx4 v233, s[24:27], s58 offen  lds
    global_load_dwordx4 v[240:243], v248, s[4:5] offset:0
    global_load_dwordx4 v[244:247], v248, s[4:5] offset:32
    s_waitcnt vmcnt(10)
    ds_read_b64_tr_b16 v[120:121], v236 offset:14336
    ds_read_b64_tr_b16 v[122:123], v236 offset:15360
    ds_read_b64_tr_b16 v[124:125], v237 offset:14336
    ds_read_b64_tr_b16 v[126:127], v237 offset:15360
    s_add_u32 s58, s9, s51
    s_add_u32 m0, s50, 4096
    s_mul_i32 s58, s58, 65536
    buffer_load_dwordx4 v232, s[24:27], s58 offen  lds
    s_add_u32 m0, s50, 5120
    s_nop 0
    buffer_load_dwordx4 v233, s[24:27], s58 offen  lds
    s_waitcnt vmcnt(10)
    ds_read_b64_tr_b16 v[128:129], v236 offset:16384
    ds_read_b64_tr_b16 v[130:131], v236 offset:17408
    ds_read_b64_tr_b16 v[132:133], v237 offset:16384
    ds_read_b64_tr_b16 v[134:135], v237 offset:17408
    s_waitcnt lgkmcnt(15)
    s_add_u32 s58, s9, s15
    s_add_u32 m0, s50, 6144
    s_mul_i32 s58, s58, 65536
    buffer_load_dwordx4 v232, s[24:27], s58 offen  lds
    s_add_u32 m0, s50, 7168
    s_nop 0
    buffer_load_dwordx4 v233, s[24:27], s58 offen  lds
    s_waitcnt vmcnt(10)
    ds_read_b64_tr_b16 v[136:137], v236 offset:18432
    ds_read_b64_tr_b16 v[138:139], v236 offset:19456
    ds_read_b64_tr_b16 v[140:141], v237 offset:18432
    ds_read_b64_tr_b16 v[142:143], v237 offset:19456
    s_add_u32 s58, s9, s59
    s_add_u32 m0, s50, 8192
    s_mul_i32 s58, s58, 65536
    buffer_load_dwordx4 v232, s[24:27], s58 offen  lds
    s_add_u32 m0, s50, 9216
    s_nop 0
    buffer_load_dwordx4 v233, s[24:27], s58 offen  lds
    s_waitcnt vmcnt(10)
    ds_read_b64_tr_b16 v[144:145], v236 offset:0
    ds_read_b64_tr_b16 v[146:147], v236 offset:1024
    ds_read_b64_tr_b16 v[148:149], v237 offset:0
    ds_read_b64_tr_b16 v[150:151], v237 offset:1024
    s_waitcnt lgkmcnt(15)
    s_add_u32 s58, s9, s3
    s_add_u32 m0, s50, 10240
    s_mul_i32 s58, s58, 65536
    buffer_load_dwordx4 v232, s[24:27], s58 offen  lds
    s_add_u32 m0, s50, 11264
    s_nop 0
    buffer_load_dwordx4 v233, s[24:27], s58 offen  lds
    s_waitcnt vmcnt(10)
    ds_read_b64_tr_b16 v[152:153], v236 offset:2048
    ds_read_b64_tr_b16 v[154:155], v236 offset:3072
    ds_read_b64_tr_b16 v[156:157], v237 offset:2048
    ds_read_b64_tr_b16 v[158:159], v237 offset:3072
    s_add_u32 s58, s10, s51
    s_add_u32 m0, s50, 12288
    s_mul_i32 s58, s58, 65536
    buffer_load_dwordx4 v232, s[24:27], s58 offen  lds
    s_add_u32 m0, s50, 13312
    s_nop 0
    buffer_load_dwordx4 v233, s[24:27], s58 offen  lds
    s_waitcnt vmcnt(8)
    ds_read_b64_tr_b16 v[160:161], v236 offset:4096
    ds_read_b64_tr_b16 v[162:163], v236 offset:5120
    ds_read_b64_tr_b16 v[164:165], v237 offset:4096
    ds_read_b64_tr_b16 v[166:167], v237 offset:5120
    s_waitcnt lgkmcnt(15)
    s_add_u32 s58, s10, s15
    s_add_u32 m0, s50, 14336
    s_mul_i32 s58, s58, 65536
    buffer_load_dwordx4 v232, s[24:27], s58 offen  lds
    s_add_u32 m0, s50, 15360
    s_nop 0
    buffer_load_dwordx4 v233, s[24:27], s58 offen  lds
    s_waitcnt vmcnt(8)
    ds_read_b64_tr_b16 v[168:169], v236 offset:6144
    ds_read_b64_tr_b16 v[170:171], v236 offset:7168
    ds_read_b64_tr_b16 v[172:173], v237 offset:6144
    ds_read_b64_tr_b16 v[174:175], v237 offset:7168
    s_add_u32 s58, s10, s59
    s_add_u32 m0, s50, 16384
    s_mul_i32 s58, s58, 65536
    buffer_load_dwordx4 v232, s[24:27], s58 offen  lds
    s_add_u32 m0, s50, 17408
    s_nop 0
    buffer_load_dwordx4 v233, s[24:27], s58 offen  lds
    s_waitcnt vmcnt(8)
    ds_read_b64_tr_b16 v[176:177], v236 offset:8192
    ds_read_b64_tr_b16 v[178:179], v236 offset:9216
    ds_read_b64_tr_b16 v[180:181], v237 offset:8192
    ds_read_b64_tr_b16 v[182:183], v237 offset:9216
    s_waitcnt lgkmcnt(15)
    s_add_u32 s58, s10, s3
    s_add_u32 m0, s50, 18432
    s_mul_i32 s58, s58, 65536
    buffer_load_dwordx4 v232, s[24:27], s58 offen  lds
    s_add_u32 m0, s50, 19456
    s_nop 0
    buffer_load_dwordx4 v233, s[24:27], s58 offen  lds
    s_waitcnt vmcnt(8)
    ds_read_b64_tr_b16 v[184:185], v236 offset:10240
    ds_read_b64_tr_b16 v[186:187], v236 offset:11264
    ds_read_b64_tr_b16 v[188:189], v237 offset:10240
    ds_read_b64_tr_b16 v[190:191], v237 offset:11264
    s_add_u32 s58, s11, s51
    s_add_u32 m0, s50, 0
    s_mul_i32 s58, s58, 65536
    buffer_load_dwordx4 v232, s[24:27], s58 offen  lds
    s_add_u32 m0, s50, 1024
    s_nop 0
    buffer_load_dwordx4 v233, s[24:27], s58 offen  lds
    s_waitcnt vmcnt(8)
    s_waitcnt lgkmcnt(15)
    s_add_u32 s58, s11, s15
    s_add_u32 m0, s50, 2048
    s_mul_i32 s58, s58, 65536
    buffer_load_dwordx4 v232, s[24:27], s58 offen  lds
    s_add_u32 m0, s50, 3072
    s_nop 0
    buffer_load_dwordx4 v233, s[24:27], s58 offen  lds
    s_waitcnt vmcnt(8)
    s_waitcnt lgkmcnt(12)
    s_add_u32 s58, s11, s59
    s_add_u32 m0, s50, 4096
    s_mul_i32 s58, s58, 65536
    buffer_load_dwordx4 v232, s[24:27], s58 offen  lds
    s_add_u32 m0, s50, 5120
    s_nop 0
    buffer_load_dwordx4 v233, s[24:27], s58 offen  lds
    s_waitcnt vmcnt(8)
    s_waitcnt lgkmcnt(8)
    s_add_u32 s58, s11, s3
    s_add_u32 m0, s50, 6144
    s_mul_i32 s58, s58, 65536
    buffer_load_dwordx4 v232, s[24:27], s58 offen  lds
    s_add_u32 m0, s50, 7168
    s_nop 0
    buffer_load_dwordx4 v233, s[24:27], s58 offen  lds
    s_waitcnt vmcnt(8)
    s_waitcnt lgkmcnt(4)
    s_add_u32 s58, s48, s51
    s_add_u32 m0, s50, 8192
    s_mul_i32 s58, s58, 65536
    buffer_load_dwordx4 v232, s[24:27], s58 offen  lds
    s_add_u32 m0, s50, 9216
    s_nop 0
    buffer_load_dwordx4 v233, s[24:27], s58 offen  lds
    s_waitcnt vmcnt(8)
    s_mov_b64 exec, 0x0fffffff
    buffer_load_dword v251, v252, s[32:35], s69 offen sc1
    s_mov_b64 exec, -1
    s_waitcnt lgkmcnt(0)
    s_add_u32 s58, s48, s15
    s_add_u32 m0, s50, 10240
    s_mul_i32 s58, s58, 65536
    buffer_load_dwordx4 v232, s[24:27], s58 offen  lds
    s_add_u32 m0, s50, 11264
    s_nop 0
    buffer_load_dwordx4 v233, s[24:27], s58 offen  lds
    v_lshlrev_b32 v16, 16, v249
    v_permlane32_swap_b32 v240, v242
    v_permlane32_swap_b32 v241, v243
    v_permlane32_swap_b32 v244, v246
    v_permlane32_swap_b32 v245, v247
    s_nop 0
    v_lshlrev_b32 v0, 16, v240
    v_and_b32 v1, 0xffff0000, v240
    v_lshlrev_b32 v2, 16, v241
    v_and_b32 v3, 0xffff0000, v241
    v_lshlrev_b32 v4, 16, v242
    v_and_b32 v5, 0xffff0000, v242
    v_lshlrev_b32 v6, 16, v243
    v_and_b32 v7, 0xffff0000, v243
    v_lshlrev_b32 v8, 16, v244
    v_and_b32 v9, 0xffff0000, v244
    v_lshlrev_b32 v10, 16, v245
    v_and_b32 v11, 0xffff0000, v245
    v_lshlrev_b32 v12, 16, v246
    v_and_b32 v13, 0xffff0000, v246
    v_lshlrev_b32 v14, 16, v247
    v_and_b32 v15, 0xffff0000, v247
    v_add_f32 v0, v0, v16
    v_add_f32 v1, v1, v16
    v_add_f32 v2, v2, v16
    v_add_f32 v3, v3, v16
    v_add_f32 v4, v4, v16
    v_add_f32 v5, v5, v16
    v_add_f32 v6, v6, v16
    v_add_f32 v7, v7, v16
    v_add_f32 v8, v8, v16
    v_add_f32 v9, v9, v16
    v_add_f32 v10, v10, v16
    v_add_f32 v11, v11, v16
    v_add_f32 v12, v12, v16
    v_add_f32 v13, v13, v16
    v_add_f32 v14, v14, v16
    v_add_f32 v15, v15, v16
    s_mov_b32 s20, s12
    s_and_b32 s21, s13, 0xffff
    s_mov_b32 s22, 1835008
    s_mov_b32 s23, 0x20000
    s_mov_b32 s63, 0x0fffffff
    s_waitcnt vmcnt(2)
    s_mov_b32 s60, 0
F4_22:
    v_cmp_ne_u32 vcc, 0, v251
    s_and_b32 s61, vcc_lo, s63
    s_cmp_eq_u32 s61, s63
    s_cbranch_scc1 F4D_23
    s_sleep 1
    s_mov_b64 exec, 0x0fffffff
    buffer_load_dword v251, v252, s[32:35], s69 offen sc1
    s_mov_b64 exec, -1
    s_add_u32 s60, s60, 1
    s_waitcnt vmcnt(0)
    s_cmp_lt_u32 s60, 0x40000
    s_cbranch_scc1 F4_22
F4D_23:
    s_add_u32 s60, s6, s51
    s_lshl_b32 s60, s60, 11
    buffer_load_dwordx4 v[192:195], v234, s[40:43], s60 offen sc1
    buffer_load_dwordx4 v[196:199], v235, s[40:43], s60 offen sc1
    s_add_u32 s60, s6, s15
    s_lshl_b32 s60, s60, 11
    buffer_load_dwordx4 v[200:203], v234, s[40:43], s60 offen sc1
    buffer_load_dwordx4 v[204:207], v235, s[40:43], s60 offen sc1
    s_add_u32 s60, s6, s59
    s_lshl_b32 s60, s60, 11
    buffer_load_dwordx4 v[208:211], v234, s[40:43], s60 offen sc1
    buffer_load_dwordx4 v[212:215], v235, s[40:43], s60 offen sc1
    s_add_u32 s60, s6, s3
    s_lshl_b32 s60, s60, 11
    buffer_load_dwordx4 v[216:219], v234, s[40:43], s60 offen sc1
    buffer_load_dwordx4 v[220:223], v235, s[40:43], s60 offen sc1
    s_add_u32 s60, s7, s51
    s_lshl_b32 s60, s60, 11
    buffer_load_dwordx4 v[224:227], v234, s[40:43], s60 offen sc1
    buffer_load_dwordx4 v[228:231], v235, s[40:43], s60 offen sc1
    s_lshl_b32 s57, s66, 16
    s_lshl_b32 s36, s14, 13
    s_add_u32 s57, s57, s36
    s_add_u32 s57, s57, 0x900000
    s_lshl_b32 s36, s14, 14
    s_and_b32 s36, s36, 0x8000
    s_xor_b32 s37, s36, 0x8000
    s_add_u32 s67, s57, s37
    s_add_u32 s57, s57, s36
    s_lshl_b32 s68, s66, 8
    s_add_u32 s68, s68, 0x84a000
    s_waitcnt vmcnt(8)
    v_mfma_f32_32x32x16_bf16 v[0:15], v[192:195], v[64:67], v[0:15]
    s_add_u32 s60, s7, s15
    s_lshl_b32 s60, s60, 11
    buffer_load_dwordx4 v[240:243], v234, s[40:43], s60 offen sc1
    v_mfma_f32_32x32x16_bf16 v[16:31], v[196:199], v[64:67], 0
    buffer_load_dwordx4 v[244:247], v235, s[40:43], s60 offen sc1
    v_mfma_f32_32x32x16_bf16 v[32:47], v[192:195], v[68:71], 0
    v_mfma_f32_32x32x16_bf16 v[48:63], v[196:199], v[68:71], 0
    s_waitcnt vmcnt(8)
    v_mfma_f32_32x32x16_bf16 v[0:15], v[200:203], v[72:75], v[0:15]
    s_add_u32 s60, s7, s59
    s_lshl_b32 s60, s60, 11
    buffer_load_dwordx4 v[192:195], v234, s[40:43], s60 offen sc1
    v_mfma_f32_32x32x16_bf16 v[16:31], v[204:207], v[72:75], v[16:31]
    buffer_load_dwordx4 v[196:199], v235, s[40:43], s60 offen sc1
    v_mfma_f32_32x32x16_bf16 v[32:47], v[200:203], v[76:79], v[32:47]
    ds_read_b64_tr_b16 v[64:65], v236 offset:12288
    ds_read_b64_tr_b16 v[66:67], v236 offset:13312
    v_mfma_f32_32x32x16_bf16 v[48:63], v[204:207], v[76:79], v[48:63]
    ds_read_b64_tr_b16 v[68:69], v237 offset:12288
    ds_read_b64_tr_b16 v[70:71], v237 offset:13312
    s_waitcnt vmcnt(8)
    v_mfma_f32_32x32x16_bf16 v[0:15], v[208:211], v[80:83], v[0:15]
    s_add_u32 s60, s7, s3
    s_lshl_b32 s60, s60, 11
    buffer_load_dwordx4 v[200:203], v234, s[40:43], s60 offen sc1
    buffer_load_dwordx4 v[204:207], v235, s[40:43], s60 offen sc1
    v_mfma_f32_32x32x16_bf16 v[16:31], v[212:215], v[80:83], v[16:31]
    ds_read_b64_tr_b16 v[72:73], v236 offset:14336
    ds_read_b64_tr_b16 v[74:75], v236 offset:15360
    v_mfma_f32_32x32x16_bf16 v[32:47], v[208:211], v[84:87], v[32:47]
    ds_read_b64_tr_b16 v[76:77], v237 offset:14336
    ds_read_b64_tr_b16 v[78:79], v237 offset:15360
    s_waitcnt lgkmcnt(4)
    s_add_u32 s58, s48, s59
    s_add_u32 m0, s50, 12288
    s_mul_i32 s58, s58, 65536
    buffer_load_dwordx4 v232, s[24:27], s58 offen  lds
    s_add_u32 m0, s50, 13312
    v_mfma_f32_32x32x16_bf16 v[48:63], v[212:215], v[84:87], v[48:63]
    s_nop 0
    buffer_load_dwordx4 v233, s[24:27], s58 offen  lds
    s_waitcnt vmcnt(10)
    v_mfma_f32_32x32x16_bf16 v[0:15], v[216:219], v[88:91], v[0:15]
    s_add_u32 s60, s8, s51
    s_lshl_b32 s60, s60, 11
    buffer_load_dwordx4 v[208:211], v234, s[40:43], s60 offen sc1
    buffer_load_dwordx4 v[212:215], v235, s[40:43], s60 offen sc1
    v_mfma_f32_32x32x16_bf16 v[16:31], v[220:223], v[88:91], v[16:31]
    ds_read_b64_tr_b16 v[80:81], v236 offset:16384
    ds_read_b64_tr_b16 v[82:83], v236 offset:17408
    v_mfma_f32_32x32x16_bf16 v[32:47], v[216:219], v[92:95], v[32:47]
    ds_read_b64_tr_b16 v[84:85], v237 offset:16384
    ds_read_b64_tr_b16 v[86:87], v237 offset:17408
    s_waitcnt lgkmcnt(4)
    s_add_u32 s58, s48, s3
    s_add_u32 m0, s50, 14336
    s_mul_i32 s58, s58, 65536
    buffer_load_dwordx4 v232, s[24:27], s58 offen  lds
    s_add_u32 m0, s50, 15360
    v_mfma_f32_32x32x16_bf16 v[48:63], v[220:223], v[92:95], v[48:63]
    s_nop 0
    buffer_load_dwordx4 v233, s[24:27], s58 offen  lds
    s_waitcnt vmcnt(12)
    v_mfma_f32_32x32x16_bf16 v[0:15], v[224:227], v[96:99], v[0:15]
    s_add_u32 s60, s8, s15
    s_lshl_b32 s60, s60, 11
    buffer_load_dwordx4 v[216:219], v234, s[40:43], s60 offen sc1
    v_mfma_f32_32x32x16_bf16 v[16:31], v[228:231], v[96:99], v[16:31]
    buffer_load_dwordx4 v[220:223], v235, s[40:43], s60 offen sc1
    v_mfma_f32_32x32x16_bf16 v[32:47], v[224:227], v[100:103], v[32:47]
    ds_read_b64_tr_b16 v[88:89], v236 offset:18432
    ds_read_b64_tr_b16 v[90:91], v236 offset:19456
    v_mfma_f32_32x32x16_bf16 v[48:63], v[228:231], v[100:103], v[48:63]
    ds_read_b64_tr_b16 v[92:93], v237 offset:18432
    ds_read_b64_tr_b16 v[94:95], v237 offset:19456
    s_waitcnt vmcnt(12)
    v_mfma_f32_32x32x16_bf16 v[0:15], v[240:243], v[104:107], v[0:15]
    s_add_u32 s60, s8, s59
    s_lshl_b32 s60, s60, 11
    buffer_load_dwordx4 v[224:227], v234, s[40:43], s60 offen sc1
    v_mfma_f32_32x32x16_bf16 v[16:31], v[244:247], v[104:107], v[16:31]
    buffer_load_dwordx4 v[228:231], v235, s[40:43], s60 offen sc1
    v_mfma_f32_32x32x16_bf16 v[32:47], v[240:243], v[108:111], v[32:47]
    ds_read_b64_tr_b16 v[96:97], v236 offset:0
    ds_read_b64_tr_b16 v[98:99], v236 offset:1024
    v_mfma_f32_32x32x16_bf16 v[48:63], v[244:247], v[108:111], v[48:63]
    ds_read_b64_tr_b16 v[100:101], v237 offset:0
    ds_read_b64_tr_b16 v[102:103], v237 offset:1024
    s_waitcnt vmcnt(12)
    v_mfma_f32_32x32x16_bf16 v[0:15], v[192:195], v[112:115], v[0:15]
    s_add_u32 s60, s8, s3
    s_lshl_b32 s60, s60, 11
    buffer_load_dwordx4 v[240:243], v234, s[40:43], s60 offen sc1
    v_mfma_f32_32x32x16_bf16 v[16:31], v[196:199], v[112:115], v[16:31]
    buffer_load_dwordx4 v[244:247], v235, s[40:43], s60 offen sc1
    v_mfma_f32_32x32x16_bf16 v[32:47], v[192:195], v[116:119], v[32:47]
    ds_read_b64_tr_b16 v[104:105], v236 offset:2048
    ds_read_b64_tr_b16 v[106:107], v236 offset:3072
    v_mfma_f32_32x32x16_bf16 v[48:63], v[196:199], v[116:119], v[48:63]
    ds_read_b64_tr_b16 v[108:109], v237 offset:2048
    ds_read_b64_tr_b16 v[110:111], v237 offset:3072
    s_waitcnt vmcnt(12)
    v_mfma_f32_32x32x16_bf16 v[0:15], v[200:203], v[120:123], v[0:15]
    s_add_u32 s60, s9, s51
    s_lshl_b32 s60, s60, 11
    buffer_load_dwordx4 v[192:195], v234, s[40:43], s60 offen sc1
    v_mfma_f32_32x32x16_bf16 v[16:31], v[204:207], v[120:123], v[16:31]
    buffer_load_dwordx4 v[196:199], v235, s[40:43], s60 offen sc1
    v_mfma_f32_32x32x16_bf16 v[32:47], v[200:203], v[124:127], v[32:47]
    ds_read_b64_tr_b16 v[112:113], v236 offset:4096
    ds_read_b64_tr_b16 v[114:115], v236 offset:5120
    v_mfma_f32_32x32x16_bf16 v[48:63], v[204:207], v[124:127], v[48:63]
    ds_read_b64_tr_b16 v[116:117], v237 offset:4096
    ds_read_b64_tr_b16 v[118:119], v237 offset:5120
    s_waitcnt vmcnt(10)
    v_mfma_f32_32x32x16_bf16 v[0:15], v[208:211], v[128:131], v[0:15]
    s_add_u32 s60, s9, s15
    s_lshl_b32 s60, s60, 11
    buffer_load_dwordx4 v[200:203], v234, s[40:43], s60 offen sc1
    v_mfma_f32_32x32x16_bf16 v[16:31], v[212:215], v[128:131], v[16:31]
    buffer_load_dwordx4 v[204:207], v235, s[40:43], s60 offen sc1
    v_mfma_f32_32x32x16_bf16 v[32:47], v[208:211], v[132:135], v[32:47]
    ds_read_b64_tr_b16 v[120:121], v236 offset:6144
    ds_read_b64_tr_b16 v[122:123], v236 offset:7168
    v_mfma_f32_32x32x16_bf16 v[48:63], v[212:215], v[132:135], v[48:63]
    ds_read_b64_tr_b16 v[124:125], v237 offset:6144
    ds_read_b64_tr_b16 v[126:127], v237 offset:7168
    s_waitcnt vmcnt(8)
    v_mfma_f32_32x32x16_bf16 v[0:15], v[216:219], v[136:139], v[0:15]
    s_add_u32 s60, s9, s59
    s_lshl_b32 s60, s60, 11
    buffer_load_dwordx4 v[208:211], v234, s[40:43], s60 offen sc1
    v_mfma_f32_32x32x16_bf16 v[16:31], v[220:223], v[136:139], v[16:31]
    buffer_load_dwordx4 v[212:215], v235, s[40:43], s60 offen sc1
    v_mfma_f32_32x32x16_bf16 v[32:47], v[216:219], v[140:143], v[32:47]
    ds_read_b64_tr_b16 v[128:129], v236 offset:8192
    ds_read_b64_tr_b16 v[130:131], v236 offset:9216
    v_mfma_f32_32x32x16_bf16 v[48:63], v[220:223], v[140:143], v[48:63]
    ds_read_b64_tr_b16 v[132:133], v237 offset:8192
    ds_read_b64_tr_b16 v[134:135], v237 offset:9216
    s_waitcnt vmcnt(8)
    v_mfma_f32_32x32x16_bf16 v[0:15], v[224:227], v[144:147], v[0:15]
    s_add_u32 s60, s9, s3
    s_lshl_b32 s60, s60, 11
    buffer_load_dwordx4 v[216:219], v234, s[40:43], s60 offen sc1
    v_mfma_f32_32x32x16_bf16 v[16:31], v[228:231], v[144:147], v[16:31]
    buffer_load_dwordx4 v[220:223], v235, s[40:43], s60 offen sc1
    v_mfma_f32_32x32x16_bf16 v[32:47], v[224:227], v[148:151], v[32:47]
    ds_read_b64_tr_b16 v[136:137], v236 offset:10240
    ds_read_b64_tr_b16 v[138:139], v236 offset:11264
    v_mfma_f32_32x32x16_bf16 v[48:63], v[228:231], v[148:151], v[48:63]
    ds_read_b64_tr_b16 v[140:141], v237 offset:10240
    ds_read_b64_tr_b16 v[142:143], v237 offset:11264
    s_waitcnt vmcnt(8)
    v_mfma_f32_32x32x16_bf16 v[0:15], v[240:243], v[152:155], v[0:15]
    s_add_u32 s60, s10, s51
    s_lshl_b32 s60, s60, 11
    buffer_load_dwordx4 v[224:227], v234, s[40:43], s60 offen sc1
    v_mfma_f32_32x32x16_bf16 v[16:31], v[244:247], v[152:155], v[16:31]
    buffer_load_dwordx4 v[228:231], v235, s[40:43], s60 offen sc1
    v_mfma_f32_32x32x16_bf16 v[32:47], v[240:243], v[156:159], v[32:47]
    ds_read_b64_tr_b16 v[144:145], v236 offset:12288
    ds_read_b64_tr_b16 v[146:147], v236 offset:13312
    v_mfma_f32_32x32x16_bf16 v[48:63], v[244:247], v[156:159], v[48:63]
    ds_read_b64_tr_b16 v[148:149], v237 offset:12288
    ds_read_b64_tr_b16 v[150:151], v237 offset:13312
    s_waitcnt vmcnt(8)
    v_mfma_f32_32x32x16_bf16 v[0:15], v[192:195], v[160:163], v[0:15]
    s_add_u32 s60, s10, s15
    s_lshl_b32 s60, s60, 11
    buffer_load_dwordx4 v[240:243], v234, s[40:43], s60 offen sc1
    buffer_load_dwordx4 v[244:247], v235, s[40:43], s60 offen sc1
    v_mfma_f32_32x32x16_bf16 v[16:31], v[196:199], v[160:163], v[16:31]
    ds_read_b64_tr_b16 v[152:153], v236 offset:14336
    ds_read_b64_tr_b16 v[154:155], v236 offset:15360
    v_mfma_f32_32x32x16_bf16 v[32:47], v[192:195], v[164:167], v[32:47]
    ds_read_b64_tr_b16 v[156:157], v237 offset:14336
    ds_read_b64_tr_b16 v[158:159], v237 offset:15360
    v_mfma_f32_32x32x16_bf16 v[48:63], v[196:199], v[164:167], v[48:63]
    buffer_load_dword v251, v250, s[32:35], s68 offen sc1
    s_waitcnt vmcnt(9)
    v_mfma_f32_32x32x16_bf16 v[0:15], v[200:203], v[168:171], v[0:15]
    s_add_u32 s60, s10, s59
    s_lshl_b32 s60, s60, 11
    buffer_load_dwordx4 v[192:195], v234, s[40:43], s60 offen sc1
    v_mfma_f32_32x32x16_bf16 v[16:31], v[204:207], v[168:171], v[16:31]
    buffer_load_dwordx4 v[196:199], v235, s[40:43], s60 offen sc1
    v_mfma_f32_32x32x16_bf16 v[32:47], v[200:203], v[172:175], v[32:47]
    buffer_load_dwordx4 v[160:163], v234, s[40:43], s56 offen offset:0 sc1
    v_mfma_f32_32x32x16_bf16 v[48:63], v[204:207], v[172:175], v[48:63]
    buffer_load_dwordx4 v[164:167], v235, s[40:43], s56 offen offset:0 sc1
    s_waitcnt vmcnt(11)
    v_mfma_f32_32x32x16_bf16 v[0:15], v[208:211], v[176:179], v[0:15]
    s_add_u32 s60, s10, s3
    s_lshl_b32 s60, s60, 11
    buffer_load_dwordx4 v[200:203], v234, s[40:43], s60 offen sc1
    v_mfma_f32_32x32x16_bf16 v[16:31], v[212:215], v[176:179], v[16:31]
    buffer_load_dwordx4 v[204:207], v235, s[40:43], s60 offen sc1
    v_mfma_f32_32x32x16_bf16 v[32:47], v[208:211], v[180:183], v[32:47]
    buffer_load_dwordx4 v[168:171], v234, s[40:43], s56 offen offset:2048 sc1
    v_mfma_f32_32x32x16_bf16 v[48:63], v[212:215], v[180:183], v[48:63]
    buffer_load_dwordx4 v[172:175], v235, s[40:43], s56 offen offset:2048 sc1
    s_waitcnt vmcnt(13)
    v_mfma_f32_32x32x16_bf16 v[0:15], v[216:219], v[184:187], v[0:15]
    s_add_u32 s60, s11, s51
    s_lshl_b32 s60, s60, 11
    buffer_load_dwordx4 v[208:211], v234, s[40:43], s60 offen sc1
    v_mfma_f32_32x32x16_bf16 v[16:31], v[220:223], v[184:187], v[16:31]
    buffer_load_dwordx4 v[212:215], v235, s[40:43], s60 offen sc1
    v_mfma_f32_32x32x16_bf16 v[32:47], v[216:219], v[188:191], v[32:47]
    s_add_u32 s56, s56, 4096
    buffer_load_dwordx4 v[176:179], v234, s[40:43], s56 offen offset:0 sc1
    v_mfma_f32_32x32x16_bf16 v[48:63], v[220:223], v[188:191], v[48:63]
    buffer_load_dwordx4 v[180:183], v235, s[40:43], s56 offen offset:0 sc1
    s_waitcnt vmcnt(15)
    v_mfma_f32_32x32x16_bf16 v[0:15], v[224:227], v[64:67], v[0:15]
    s_add_u32 s60, s11, s15
    s_lshl_b32 s60, s60, 11
    buffer_load_dwordx4 v[216:219], v234, s[40:43], s60 offen sc1
    v_mfma_f32_32x32x16_bf16 v[16:31], v[228:231], v[64:67], v[16:31]
    buffer_load_dwordx4 v[220:223], v235, s[40:43], s60 offen sc1
    v_mfma_f32_32x32x16_bf16 v[32:47], v[224:227], v[68:71], v[32:47]
    buffer_load_dwordx4 v[184:187], v234, s[40:43], s56 offen offset:2048 sc1
    v_mfma_f32_32x32x16_bf16 v[48:63], v[228:231], v[68:71], v[48:63]
    buffer_load_dwordx4 v[188:191], v235, s[40:43], s56 offen offset:2048 sc1
    s_waitcnt vmcnt(16)
    v_readfirstlane_b32 s62, v251
    s_cmp_lg_u32 s62, 0
    s_cbranch_scc1 G_S2_OK
    s_mov_b32 s60, 0
    s_mov_b64 exec, 1
POLL_24:
    buffer_load_dword v251, v250, s[32:35], s68 offen sc1
    s_add_u32 s60, s60, 1
    s_waitcnt vmcnt(0)
    v_readfirstlane_b32 s61, v251
    s_cmp_ge_u32 s61, 1
    s_cbranch_scc1 POLLD_25
    s_sleep 2
    s_cmp_lt_u32 s60, 0x40000
    s_cbranch_scc1 POLL_24
POLLD_25:
    s_mov_b64 exec, -1
G_S2_OK:
    v_mfma_f32_32x32x16_bf16 v[0:15], v[240:243], v[72:75], v[0:15]
    s_add_u32 s60, s11, s59
    s_lshl_b32 s60, s60, 11
    buffer_load_dwordx4 v[224:227], v234, s[40:43], s60 offen sc1
    v_mfma_f32_32x32x16_bf16 v[16:31], v[244:247], v[72:75], v[16:31]
    buffer_load_dwordx4 v[228:231], v235, s[40:43], s60 offen sc1
    v_mfma_f32_32x32x16_bf16 v[32:47], v[240:243], v[76:79], v[32:47]
    buffer_load_dwordx4 v[64:67], v239, s[32:35], s57 offen offset:0 sc1
    v_mfma_f32_32x32x16_bf16 v[48:63], v[244:247], v[76:79], v[48:63]
    buffer_load_dwordx4 v[68:71], v239, s[32:35], s67 offen offset:0 sc1
    s_waitcnt vmcnt(18) lgkmcnt(15)
    v_mfma_f32_32x32x16_bf16 v[0:15], v[192:195], v[80:83], v[0:15]
    s_add_u32 s60, s11, s3
    s_lshl_b32 s60, s60, 11
    buffer_load_dwordx4 v[240:243], v234, s[40:43], s60 offen sc1
    v_mfma_f32_32x32x16_bf16 v[16:31], v[196:199], v[80:83], v[16:31]
    buffer_load_dwordx4 v[244:247], v235, s[40:43], s60 offen sc1
    v_mfma_f32_32x32x16_bf16 v[32:47], v[192:195], v[84:87], v[32:47]
    buffer_load_dwordx4 v[72:75], v239, s[32:35], s57 offen offset:1024 sc1
    v_mfma_f32_32x32x16_bf16 v[48:63], v[196:199], v[84:87], v[48:63]
    buffer_load_dwordx4 v[76:79], v239, s[32:35], s67 offen offset:1024 sc1
    s_waitcnt vmcnt(18)
    v_mfma_f32_32x32x16_bf16 v[0:15], v[200:203], v[88:91], v[0:15]
    s_add_u32 s60, s48, s51
    s_lshl_b32 s60, s60, 11
    buffer_load_dwordx4 v[192:195], v234, s[40:43], s60 offen sc1
    v_mfma_f32_32x32x16_bf16 v[16:31], v[204:207], v[88:91], v[16:31]
    buffer_load_dwordx4 v[196:199], v235, s[40:43], s60 offen sc1
    v_mfma_f32_32x32x16_bf16 v[32:47], v[200:203], v[92:95], v[32:47]
    buffer_load_dwordx4 v[80:83], v239, s[32:35], s57 offen offset:2048 sc1
    v_mfma_f32_32x32x16_bf16 v[48:63], v[204:207], v[92:95], v[48:63]
    buffer_load_dwordx4 v[84:87], v239, s[32:35], s67 offen offset:2048 sc1
    s_waitcnt vmcnt(18)
    v_mfma_f32_32x32x16_bf16 v[0:15], v[208:211], v[96:99], v[0:15]
    s_add_u32 s60, s48, s15
    s_lshl_b32 s60, s60, 11
    buffer_load_dwordx4 v[200:203], v234, s[40:43], s60 offen sc1
    v_mfma_f32_32x32x16_bf16 v[16:31], v[212:215], v[96:99], v[16:31]
    buffer_load_dwordx4 v[204:207], v235, s[40:43], s60 offen sc1
    v_mfma_f32_32x32x16_bf16 v[32:47], v[208:211], v[100:103], v[32:47]
    buffer_load_dwordx4 v[88:91], v239, s[32:35], s57 offen offset:3072 sc1
    v_mfma_f32_32x32x16_bf16 v[48:63], v[212:215], v[100:103], v[48:63]
    buffer_load_dwordx4 v[92:95], v239, s[32:35], s67 offen offset:3072 sc1
    s_waitcnt vmcnt(18)
    v_mfma_f32_32x32x16_bf16 v[0:15], v[216:219], v[104:107], v[0:15]
    s_add_u32 s60, s48, s59
    s_lshl_b32 s60, s60, 11
    buffer_load_dwordx4 v[208:211], v234, s[40:43], s60 offen sc1
    v_mfma_f32_32x32x16_bf16 v[16:31], v[220:223], v[104:107], v[16:31]
    buffer_load_dwordx4 v[212:215], v235, s[40:43], s60 offen sc1
    v_mfma_f32_32x32x16_bf16 v[32:47], v[216:219], v[108:111], v[32:47]
    s_add_u32 s56, s56, 4096
    buffer_load_dwordx4 v[96:99], v234, s[40:43], s56 offen offset:0 sc1
    v_mfma_f32_32x32x16_bf16 v[48:63], v[220:223], v[108:111], v[48:63]
    buffer_load_dwordx4 v[100:103], v235, s[40:43], s56 offen offset:0 sc1
    s_waitcnt vmcnt(18)
    v_mfma_f32_32x32x16_bf16 v[0:15], v[224:227], v[112:115], v[0:15]
    s_add_u32 s60, s48, s3
    s_lshl_b32 s60, s60, 11
    buffer_load_dwordx4 v[216:219], v234, s[40:43], s60 offen sc1
    v_mfma_f32_32x32x16_bf16 v[16:31], v[228:231], v[112:115], v[16:31]
    buffer_load_dwordx4 v[220:223], v235, s[40:43], s60 offen sc1
    v_mfma_f32_32x32x16_bf16 v[32:47], v[224:227], v[116:119], v[32:47]
    s_add_u32 s57, s57, 4096
    s_add_u32 s67, s67, 4096
    buffer_load_dwordx4 v[104:107], v239, s[32:35], s57 offen offset:0 sc1
    v_mfma_f32_32x32x16_bf16 v[48:63], v[228:231], v[116:119], v[48:63]
    buffer_load_dwordx4 v[108:111], v239, s[32:35], s67 offen offset:0 sc1
    s_waitcnt vmcnt(20)
    v_mfma_f32_32x32x16_bf16 v[0:15], v[160:163], v[64:67], v[0:15]
    buffer_load_dwordx4 v[112:115], v234, s[40:43], s56 offen offset:2048 sc1
    v_mfma_f32_32x32x16_bf16 v[16:31], v[164:167], v[64:67], v[16:31]
    buffer_load_dwordx4 v[116:119], v235, s[40:43], s56 offen offset:2048 sc1
    v_mfma_f32_32x32x16_bf16 v[32:47], v[160:163], v[68:71], v[32:47]
    buffer_load_dwordx4 v[224:227], v239, s[32:35], s57 offen offset:1024 sc1
    v_mfma_f32_32x32x16_bf16 v[48:63], v[164:167], v[68:71], v[48:63]
    buffer_load_dwordx4 v[228:231], v239, s[32:35], s67 offen offset:1024 sc1
    s_waitcnt vmcnt(22)
    v_mfma_f32_32x32x16_bf16 v[0:15], v[240:243], v[120:123], v[0:15]
    v_mfma_f32_32x32x16_bf16 v[16:31], v[244:247], v[120:123], v[16:31]
    v_mfma_f32_32x32x16_bf16 v[32:47], v[240:243], v[124:127], v[32:47]
    v_mfma_f32_32x32x16_bf16 v[48:63], v[244:247], v[124:127], v[48:63]
    s_waitcnt vmcnt(20)
    v_mfma_f32_32x32x16_bf16 v[0:15], v[168:171], v[72:75], v[0:15]
    s_add_u32 s56, s56, 4096
    buffer_load_dwordx4 v[64:67], v234, s[40:43], s56 offen offset:0 sc1
    v_mfma_f32_32x32x16_bf16 v[16:31], v[172:175], v[72:75], v[16:31]
    buffer_load_dwordx4 v[68:71], v235, s[40:43], s56 offen offset:0 sc1
    v_mfma_f32_32x32x16_bf16 v[32:47], v[168:171], v[76:79], v[32:47]
    buffer_load_dwordx4 v[120:123], v239, s[32:35], s57 offen offset:2048 sc1
    v_mfma_f32_32x32x16_bf16 v[48:63], v[172:175], v[76:79], v[48:63]
    buffer_load_dwordx4 v[124:127], v239, s[32:35], s67 offen offset:2048 sc1
    s_waitcnt vmcnt(22) lgkmcnt(12)
    v_mfma_f32_32x32x16_bf16 v[0:15], v[192:195], v[128:131], v[0:15]
    buffer_load_dwordx4 v[160:163], v234, s[40:43], s56 offen offset:2048 sc1
    v_mfma_f32_32x32x16_bf16 v[16:31], v[196:199], v[128:131], v[16:31]
    buffer_load_dwordx4 v[164:167], v235, s[40:43], s56 offen offset:2048 sc1
    v_mfma_f32_32x32x16_bf16 v[32:47], v[192:195], v[132:135], v[32:47]
    buffer_load_dwordx4 v[240:243], v239, s[32:35], s57 offen offset:3072 sc1
    v_mfma_f32_32x32x16_bf16 v[48:63], v[196:199], v[132:135], v[48:63]
    buffer_load_dwordx4 v[244:247], v239, s[32:35], s67 offen offset:3072 sc1
    s_waitcnt vmcnt(24)
    v_mfma_f32_32x32x16_bf16 v[0:15], v[176:179], v[80:83], v[0:15]
    v_mfma_f32_32x32x16_bf16 v[16:31], v[180:183], v[80:83], v[16:31]
    v_mfma_f32_32x32x16_bf16 v[32:47], v[176:179], v[84:87], v[32:47]
    v_mfma_f32_32x32x16_bf16 v[48:63], v[180:183], v[84:87], v[48:63]
    s_waitcnt vmcnt(22) lgkmcnt(8)
    v_mfma_f32_32x32x16_bf16 v[0:15], v[200:203], v[136:139], v[0:15]
    v_mfma_f32_32x32x16_bf16 v[16:31], v[204:207], v[136:139], v[16:31]
    v_mfma_f32_32x32x16_bf16 v[32:47], v[200:203], v[140:143], v[32:47]
    v_mfma_f32_32x32x16_bf16 v[48:63], v[204:207], v[140:143], v[48:63]
    s_waitcnt vmcnt(20)
    v_mfma_f32_32x32x16_bf16 v[0:15], v[184:187], v[88:91], v[0:15]
    v_mfma_f32_32x32x16_bf16 v[16:31], v[188:191], v[88:91], v[16:31]
    v_mfma_f32_32x32x16_bf16 v[32:47], v[184:187], v[92:95], v[32:47]
    v_mfma_f32_32x32x16_bf16 v[48:63], v[188:191], v[92:95], v[48:63]
    s_waitcnt vmcnt(18) lgkmcnt(4)
    v_mfma_f32_32x32x16_bf16 v[0:15], v[208:211], v[144:147], v[0:15]
    v_mfma_f32_32x32x16_bf16 v[16:31], v[212:215], v[144:147], v[16:31]
    v_mfma_f32_32x32x16_bf16 v[32:47], v[208:211], v[148:151], v[32:47]
    v_mfma_f32_32x32x16_bf16 v[48:63], v[212:215], v[148:151], v[48:63]
    s_waitcnt vmcnt(14) lgkmcnt(0)
    v_mfma_f32_32x32x16_bf16 v[0:15], v[216:219], v[152:155], v[0:15]
    v_mfma_f32_32x32x16_bf16 v[16:31], v[220:223], v[152:155], v[16:31]
    v_mfma_f32_32x32x16_bf16 v[32:47], v[216:219], v[156:159], v[32:47]
    v_mfma_f32_32x32x16_bf16 v[48:63], v[220:223], v[156:159], v[48:63]
    s_waitcnt vmcnt(12)
    v_mfma_f32_32x32x16_bf16 v[0:15], v[96:99], v[104:107], v[0:15]
    v_mfma_f32_32x32x16_bf16 v[16:31], v[100:103], v[104:107], v[16:31]
    v_mfma_f32_32x32x16_bf16 v[32:47], v[96:99], v[108:111], v[32:47]
    v_mfma_f32_32x32x16_bf16 v[48:63], v[100:103], v[108:111], v[48:63]
    s_waitcnt vmcnt(8)
    s_waitcnt vmcnt(4)
    s_waitcnt vmcnt(0)
    v_add_u32 v251, s50, v239
    v_mfma_f32_32x32x16_bf16 v[16:31], v[116:119], v[224:227], v[16:31]
    v_mfma_f32_32x32x16_bf16 v[16:31], v[68:71], v[120:123], v[16:31]
    v_mfma_f32_32x32x16_bf16 v[16:31], v[164:167], v[240:243], v[16:31]
    v_mfma_f32_32x32x16_bf16 v[32:47], v[112:115], v[228:231], v[32:47]
    s_nop 10
    ds_write_b128 v251, v[16:19] offset:8192
    v_mfma_f32_32x32x16_bf16 v[32:47], v[64:67], v[124:127], v[32:47]
    ds_write_b128 v251, v[20:23] offset:9216
    ds_write_b128 v251, v[24:27] offset:10240
    v_mfma_f32_32x32x16_bf16 v[32:47], v[160:163], v[244:247], v[32:47]
    ds_write_b128 v251, v[28:31] offset:11264
    v_mfma_f32_32x32x16_bf16 v[48:63], v[116:119], v[228:231], v[48:63]
    s_nop 10
    ds_write_b128 v251, v[32:35] offset:12288
    v_mfma_f32_32x32x16_bf16 v[48:63], v[68:71], v[124:127], v[48:63]
    ds_write_b128 v251, v[36:39] offset:13312
    ds_write_b128 v251, v[40:43] offset:14336
    v_mfma_f32_32x32x16_bf16 v[48:63], v[164:167], v[244:247], v[48:63]
    ds_write_b128 v251, v[44:47] offset:15360
    v_mfma_f32_32x32x16_bf16 v[0:15], v[112:115], v[224:227], v[0:15]
    s_nop 10
    ds_write_b128 v251, v[48:51] offset:16384
    v_mfma_f32_32x32x16_bf16 v[0:15], v[64:67], v[120:123], v[0:15]
    ds_write_b128 v251, v[52:55] offset:17408
    ds_write_b128 v251, v[56:59] offset:18432
    v_mfma_f32_32x32x16_bf16 v[0:15], v[160:163], v[240:243], v[0:15]
    ds_write_b128 v251, v[60:63] offset:19456
    s_xor_b32 s60, s14, 1
    s_mul_i32 s60, s60, 20480
    v_add_u32 v252, s60, v239
    s_xor_b32 s60, s14, 2
    s_mul_i32 s60, s60, 20480
    v_add_u32 v253, s60, v239
    s_xor_b32 s60, s14, 3
    s_mul_i32 s60, s60, 20480
    v_add_u32 v254, s60, v239
    s_waitcnt lgkmcnt(0)
    s_barrier
    ds_read_b128 v[16:19], v252 offset:8192
    ds_read_b128 v[20:23], v252 offset:9216
    ds_read_b128 v[24:27], v252 offset:10240
    ds_read_b128 v[28:31], v252 offset:11264
    ds_read_b128 v[32:35], v253 offset:12288
    ds_read_b128 v[36:39], v253 offset:13312
    ds_read_b128 v[40:43], v253 offset:14336
    ds_read_b128 v[44:47], v253 offset:15360
    ds_read_b128 v[48:51], v254 offset:16384
    ds_read_b128 v[52:55], v254 offset:17408
    ds_read_b128 v[56:59], v254 offset:18432
    ds_read_b128 v[60:63], v254 offset:19456
    s_waitcnt lgkmcnt(8)
    v_pk_add_f32 v[0:1], v[0:1], v[16:17]
    v_pk_add_f32 v[2:3], v[2:3], v[18:19]
    v_pk_add_f32 v[4:5], v[4:5], v[20:21]
    v_pk_add_f32 v[6:7], v[6:7], v[22:23]
    v_pk_add_f32 v[8:9], v[8:9], v[24:25]
    v_pk_add_f32 v[10:11], v[10:11], v[26:27]
    v_pk_add_f32 v[12:13], v[12:13], v[28:29]
    v_pk_add_f32 v[14:15], v[14:15], v[30:31]
    s_waitcnt lgkmcnt(4)
    v_pk_add_f32 v[0:1], v[0:1], v[32:33]
    v_pk_add_f32 v[2:3], v[2:3], v[34:35]
    v_pk_add_f32 v[4:5], v[4:5], v[36:37]
    v_pk_add_f32 v[6:7], v[6:7], v[38:39]
    v_pk_add_f32 v[8:9], v[8:9], v[40:41]
    v_pk_add_f32 v[10:11], v[10:11], v[42:43]
    v_pk_add_f32 v[12:13], v[12:13], v[44:45]
    v_pk_add_f32 v[14:15], v[14:15], v[46:47]
    s_waitcnt lgkmcnt(0)
    v_pk_add_f32 v[0:1], v[0:1], v[48:49]
    v_pk_add_f32 v[2:3], v[2:3], v[50:51]
    v_pk_add_f32 v[4:5], v[4:5], v[52:53]
    v_pk_add_f32 v[6:7], v[6:7], v[54:55]
    v_pk_add_f32 v[8:9], v[8:9], v[56:57]
    v_pk_add_f32 v[10:11], v[10:11], v[58:59]
    v_pk_add_f32 v[12:13], v[12:13], v[60:61]
    v_pk_add_f32 v[14:15], v[14:15], v[62:63]
    v_cvt_pk_bf16_f32 v32, v0, v1
    v_cvt_pk_bf16_f32 v33, v2, v3
    v_cvt_pk_bf16_f32 v34, v4, v5
    v_cvt_pk_bf16_f32 v35, v6, v7
    v_cvt_pk_bf16_f32 v36, v8, v9
    v_cvt_pk_bf16_f32 v37, v10, v11
    v_cvt_pk_bf16_f32 v38, v12, v13
    v_cvt_pk_bf16_f32 v39, v14, v15
    s_nop 1
    v_permlane32_swap_b32 v32, v34
    v_permlane32_swap_b32 v33, v35
    v_permlane32_swap_b32 v36, v38
    v_permlane32_swap_b32 v37, v39
    buffer_store_dwordx4 v[32:35], v248, s[20:23], 0 offen offset:0
    buffer_store_dwordx4 v[36:39], v248, s[20:23], 0 offen offset:32
K_END:
    s_endpgm
ROLE_P:
    s_lshl_b32 s36, s36, 2
    s_add_u32 s36, s36, s14
    v_and_b32 v1, 63, v0
    v_lshrrev_b32 v2, 3, v1
    v_and_b32 v3, 7, v1
    v_lshlrev_b32 v3, 4, v3
    s_mov_b32 s19, 0x20000
    s_lshl_b32 s49, s14, 12
    s_mov_b32 s66, 0
    s_cmp_ge_u32 s36, 196
    s_cbranch_scc1 P_JPHI
    s_mul_i32 s37, s36, 4682
    s_lshr_b32 s37, s37, 16
    s_mul_i32 s38, s37, 14
    s_sub_u32 s38, s36, s38
    s_add_u32 s38, s38, 7
P_JW:
    s_mov_b32 s67, 0
    s_mul_i32 s20, s37, 86016
    s_lshl_b32 s39, s38, 7
    s_add_u32 s20, s20, s39
    s_add_u32 s21, s20, 43008
    s_movk_i32 s50, 2688
    s_mov_b32 s18, 1204224
    s_mov_b32 s51, 8
    s_waitcnt lgkmcnt(0)
    s_mov_b32 s16, s6
    s_and_b32 s17, s7, 0xffff
    s_branch P_LD
P_JPHI:
    s_mov_b32 s67, 2
    s_sub_u32 s38, s36, 196
    s_mul_i32 s20, s38, 1568
    s_add_u32 s21, s20, 896
    s_movk_i32 s50, 56
    s_mov_b32 s51, 4
    s_cmp_lt_u32 s38, 16
    s_cselect_b32 s18, 25088, 0
    s_waitcnt lgkmcnt(0)
    s_mov_b32 s16, s8
    s_and_b32 s17, s9, 0xffff
    s_branch P_LD
P_PASS1:
    s_mul_i32 s37, s36, 9363
    s_lshr_b32 s37, s37, 16
    s_mul_i32 s38, s37, 7
    s_sub_u32 s38, s36, s38
    s_cmp_lt_u32 s36, 98
    s_cbranch_scc1 P_JW
    s_mov_b32 s67, 1
    s_sub_u32 s37, s36, 98
    s_and_b32 s38, s37, 15
    s_lshr_b32 s37, s37, 4
    s_mul_i32 s20, s38, 25088
    s_lshl_b32 s39, s37, 7
    s_add_u32 s20, s20, s39
    s_add_u32 s21, s20, 14336
    s_movk_i32 s50, 896
    s_mov_b32 s51, 4
    s_cmp_lt_u32 s37, 7
    s_cselect_b32 s18, 401408, 0
    s_mov_b32 s16, s10
    s_and_b32 s17, s11, 0xffff
P_LD:
    v_mov_b32 v4, 0x7ff00000
    v_mul_lo_u32 v8, v2, s50
    s_lshl_b32 s39, s50, 3
    v_add_u32 v8, v8, v3
    v_cmp_gt_u32 vcc, s51, v2
    v_add_u32 v9, s39, v8
    s_mov_b32 m0, s49
    v_cndmask_b32 v10, v4, v9, vcc
    buffer_load_dwordx4 v8, s[16:19], s20 offen lds
    s_add_u32 m0, s49, 1024
    s_nop 0
    buffer_load_dwordx4 v9, s[16:19], s20 offen lds
    s_add_u32 m0, s49, 2048
    s_nop 0
    buffer_load_dwordx4 v8, s[16:19], s21 offen lds
    s_add_u32 m0, s49, 3072
    s_nop 0
    buffer_load_dwordx4 v10, s[16:19], s21 offen lds
    s_cmp_lt_u32 s57, 28
    s_cbranch_scc1 P_NOCODE
    s_cmp_lg_u32 s66, 1
    s_cbranch_scc1 P_NOCODE
    s_getpc_b64 s[60:61]
K_PC:
    s_sub_u32 s60, s60, K_PC-parallel_sum__linear_kernel_hedgehog__mixer_token_mlp__prompt_kernel
    s_subb_u32 s61, s61, 0
    s_and_b32 s58, s57, 3
    s_lshl_b32 s58, s58, 12
    v_lshl_add_u32 v5, v0, 4, s58
    global_load_dwordx4 v[64:67], v5, s[60:61]
    v_add_u32 v5, 0x4000, v5
    v_min_u32 v5, CODE_END-parallel_sum__linear_kernel_hedgehog__mixer_token_mlp__prompt_kernel-16, v5
    global_load_dwordx4 v[68:71], v5, s[60:61]
P_NOCODE:
    s_mov_b32 s32, s30
    s_and_b32 s33, s31, 0xffff
    s_mov_b32 s34, 0x1000000
    s_mov_b32 s35, 0x20000
    s_mov_b32 s44, s28
    s_and_b32 s45, s29, 0xffff
    s_mov_b32 s46, 256
    s_mov_b32 s47, 0x20000
    s_mov_b64 s[64:65], -1
    v_mov_b32 v5, 0
    v_bfe_u32 v13, v1, 2, 2
    v_lshlrev_b32 v13, 7, v13
    v_lshrrev_b32 v14, 4, v1
    v_lshl_add_u32 v13, v14, 5, v13
    v_and_b32 v14, 3, v1
    v_lshl_add_u32 v13, v14, 3, v13
    v_add_u32 v13, s49, v13
    s_cmp_lg_u32 s67, 0
    s_cbranch_scc1 P_D2
    s_mul_i32 s39, s38, 37
    s_lshr_b32 s39, s39, 8
    s_mul_i32 s48, s39, 7
    s_sub_u32 s48, s38, s48
    s_lshl_b32 s48, s48, 6
    v_add_u32 v6, s48, v1
    v_mul_u32_u24 v7, 2341, v6
    v_lshrrev_b32 v7, 16, v7
    v_mul_u32_u24 v11, 28, v7
    v_sub_u32 v11, v6, v11
    v_lshlrev_b32 v11, 4, v11
    v_mul_u32_u24 v7, 77824, v7
    v_add_u32 v11, v11, v7
    v_add_u32 v12, 448, v11
    s_cmp_eq_u32 s39, 0
    s_cselect_b32 s48, 1, 2
    s_mul_i32 s48, s48, 896
    s_mul_i32 s24, s39, 896
    s_sub_u32 s24, s24, 896
    s_cmp_eq_u32 s39, 0
    s_cselect_b32 s24, 50176, s24
    s_lshl_b32 s37, s37, 1
    s_mul_i32 s37, s37, s48
    s_add_u32 s24, s24, s37
    s_add_u32 s24, s24, 0x400000
    s_add_u32 s25, s24, s48
    v_add_u32 v14, 512, v13
    v_add_u32 v15, 1024, v13
    s_branch P_ST
P_D2:
    v_add_u32 v14, 1024, v13
    v_add_u32 v15, 512, v13
    v_lshrrev_b32 v6, 5, v1
    v_and_b32 v7, 31, v1
    v_lshlrev_b32 v11, 4, v7
    s_cmp_eq_u32 s67, 2
    s_cbranch_scc1 P_D3
    v_lshl_add_u32 v11, v6, 10, v11
    v_add_u32 v12, 512, v11
    s_mul_i32 s24, s37, 294912
    s_lshl_b32 s39, s38, 12
    s_add_u32 s24, s24, s39
    s_add_u32 s24, s24, 0x638000
    s_cmp_lt_u32 s37, 7
    s_cselect_b32 s24, s24, 0x08000000
    s_add_u32 s25, s24, 2048
    s_branch P_ST
P_D3:
    v_mul_u32_u24 v6, 0x7f0000, v6
    v_lshl_add_u32 v11, v6, 4, v11
    v_add_u32 v12, 512, v11
    s_mul_i32 s24, s38, 77824
    s_add_u32 s24, s24, 0x412600
    s_cmp_lt_u32 s38, 16
    s_cselect_b32 s24, s24, 0x08000000
    s_add_u32 s25, s24, 1024
    s_mov_b32 s64, 0x0fffffff
P_ST:
    s_waitcnt vmcnt(2)
    ds_read_b64_tr_b16 v[16:17], v13 offset:0
    ds_read_b64_tr_b16 v[18:19], v14 offset:0
    ds_read_b64_tr_b16 v[20:21], v15 offset:0
    ds_read_b64_tr_b16 v[22:23], v13 offset:1536
    s_waitcnt vmcnt(0)
    ds_read_b64_tr_b16 v[24:25], v13 offset:2048
    ds_read_b64_tr_b16 v[26:27], v14 offset:2048
    ds_read_b64_tr_b16 v[28:29], v15 offset:2048
    ds_read_b64_tr_b16 v[30:31], v13 offset:3584
    s_waitcnt lgkmcnt(0)
    v_cndmask_b32 v16, 0, v16, s[64:65]
    v_cndmask_b32 v17, 0, v17, s[64:65]
    v_cndmask_b32 v18, 0, v18, s[64:65]
    v_cndmask_b32 v19, 0, v19, s[64:65]
    v_cndmask_b32 v20, 0, v20, s[64:65]
    v_cndmask_b32 v21, 0, v21, s[64:65]
    v_cndmask_b32 v22, 0, v22, s[64:65]
    v_cndmask_b32 v23, 0, v23, s[64:65]
    buffer_store_dwordx4 v[16:19], v11, s[32:35], s24 offen sc1
    buffer_store_dwordx4 v[20:23], v12, s[32:35], s24 offen sc1
    v_cndmask_b32 v24, 0, v24, s[64:65]
    v_cndmask_b32 v25, 0, v25, s[64:65]
    v_cndmask_b32 v26, 0, v26, s[64:65]
    v_cndmask_b32 v27, 0, v27, s[64:65]
    v_cndmask_b32 v28, 0, v28, s[64:65]
    v_cndmask_b32 v29, 0, v29, s[64:65]
    v_cndmask_b32 v30, 0, v30, s[64:65]
    v_cndmask_b32 v31, 0, v31, s[64:65]
    buffer_store_dwordx4 v[24:27], v11, s[32:35], s25 offen sc1
    buffer_store_dwordx4 v[28:31], v12, s[32:35], s25 offen sc1
    buffer_load_dword v4, v5, s[44:47], 0 offen sc1
    s_waitcnt vmcnt(0) lgkmcnt(0)
    s_barrier
    s_cmp_lg_u32 s14, 3
    s_cbranch_scc1 P_NEXT
    v_readfirstlane_b32 s61, v4
    s_cmp_lg_u32 s61, 0
    s_cbranch_scc1 P_RDY
    s_mov_b32 s60, 0
    s_mov_b64 exec, 1
POLL_26:
    buffer_load_dword v4, v5, s[44:47], 0 offen sc1
    s_add_u32 s60, s60, 1
    s_waitcnt vmcnt(0)
    v_readfirstlane_b32 s61, v4
    s_cmp_ge_u32 s61, 1
    s_cbranch_scc1 POLLD_27
    s_sleep 1
    s_cmp_lt_u32 s60, 0x40000
    s_cbranch_scc1 POLL_26
POLLD_27:
    s_mov_b64 exec, -1
P_RDY:
    s_mul_i32 s20, s66, 2048
    s_add_u32 s20, s20, 0x842000
    s_mov_b32 s62, 1
    s_atomic_add s62, s[30:31], s20 glc
    s_waitcnt lgkmcnt(0)
    s_cmp_lg_u32 s62, 59
    s_cbranch_scc1 P_NEXT
    s_mov_b32 s62, 1
    s_atomic_add s62, s[30:31], s20 offset:4096
    s_atomic_add s62, s[30:31], s20 offset:4352
    s_atomic_add s62, s[30:31], s20 offset:4608
    s_atomic_add s62, s[30:31], s20 offset:4864
    s_atomic_add s62, s[30:31], s20 offset:5120
    s_atomic_add s62, s[30:31], s20 offset:5376
    s_atomic_add s62, s[30:31], s20 offset:5632
    s_atomic_add s62, s[30:31], s20 offset:5888
P_NEXT:
    s_add_u32 s66, s66, 1
    s_cmp_eq_u32 s66, 1
    s_cbranch_scc1 P_PASS1
P_NOARR:
    s_cmp_lt_u32 s57, 28
    s_cbranch_scc1 ROLE_G
    s_and_b32 s36, s57, 3
    s_lshl_b32 s37, s56, 2
    s_add_u32 s37, s37, s36
    s_lshl_b32 s37, s37, 7
    s_mul_i32 s58, s14, 229376
    s_add_u32 s58, s58, s37
    s_add_u32 s58, s58, 6422528
    s_cmp_eq_u32 s56, 7
    s_cselect_b32 s58, 0x08000000, s58
    v_mul_u32_u24 v6, 3584, v2
    v_add_u32 v6, v6, v3
    s_mov_b32 s16, s40
    s_and_b32 s17, s41, 0xffff
    s_mov_b32 s18, 7340032
    s_mov_b32 s19, 0x20000
    buffer_load_dwordx4 v[16:19], v6, s[16:19], s58 offen
    s_add_u32 s58, s58, 28672
    buffer_load_dwordx4 v[20:23], v6, s[16:19], s58 offen
    s_add_u32 s58, s58, 28672
    buffer_load_dwordx4 v[24:27], v6, s[16:19], s58 offen
    s_add_u32 s58, s58, 28672
    buffer_load_dwordx4 v[28:31], v6, s[16:19], s58 offen
    s_add_u32 s58, s58, 28672
    buffer_load_dwordx4 v[32:35], v6, s[16:19], s58 offen
    s_add_u32 s58, s58, 28672
    buffer_load_dwordx4 v[36:39], v6, s[16:19], s58 offen
    s_add_u32 s58, s58, 28672
    buffer_load_dwordx4 v[40:43], v6, s[16:19], s58 offen
    s_add_u32 s58, s58, 28672
    buffer_load_dwordx4 v[44:47], v6, s[16:19], s58 offen
    s_add_u32 s58, s58, 28672
    s_lshl_b32 s36, s36, 2
    s_add_u32 s36, s36, s14
    v_lshrrev_b32 v2, 5, v1
    v_lshlrev_b32 v2, 12, v2
    v_and_b32 v3, 31, v1
    v_lshl_add_u32 v2, v3, 4, v2
    s_lshl_b32 s58, s56, 9
    v_add_u32 v2, s58, v2
    v_lshlrev_b32 v1, 4, v1
    v_mov_b32 v3, 0
    s_mul_i32 s37, s56, 229376
    s_mov_b32 s24, s52
    s_and_b32 s25, s53, 0xffff
    s_mov_b32 s26, 7340032
    s_mov_b32 s27, 0x20000
    s_add_u32 s16, s4, s37
    s_addc_u32 s17, s5, 0
    s_and_b32 s17, s17, 0xffff
    s_mov_b32 s18, 229376
    s_mov_b32 s19, 0x20000
    s_setprio 0
    s_movk_i32 s58, 0x80
    s_mov_b32 s60, 0
    s_mov_b64 exec, 1
POLL_28:
    buffer_load_dword v4, v3, s[44:47], s58 offen sc1
    s_add_u32 s60, s60, 1
    s_waitcnt vmcnt(0)
    v_readfirstlane_b32 s61, v4
    s_cmp_ge_u32 s61, 1
    s_cbranch_scc1 POLLD_29
    s_sleep 8
    s_cmp_lt_u32 s60, 0x40000
    s_cbranch_scc1 POLL_28
POLLD_29:
    s_mov_b64 exec, -1
    s_lshl_b32 s58, s36, 13
P_W2:
    s_waitcnt vmcnt(7)
    buffer_load_dwordx4 v[8:11], v2, s[24:27], s58 offen
    s_add_u32 s58, s58, 131072
    s_waitcnt vmcnt(7)
    buffer_load_dwordx4 v[12:15], v2, s[24:27], s58 offen
    s_add_u32 s58, s58, 131072
    s_waitcnt vmcnt(7)
    buffer_load_dwordx4 v[16:19], v2, s[24:27], s58 offen
    s_add_u32 s58, s58, 131072
    s_waitcnt vmcnt(7)
    buffer_load_dwordx4 v[20:23], v2, s[24:27], s58 offen
    s_add_u32 s58, s58, 131072
    s_waitcnt vmcnt(7)
    buffer_load_dwordx4 v[24:27], v2, s[24:27], s58 offen
    s_add_u32 s58, s58, 131072
    s_waitcnt vmcnt(7)
    buffer_load_dwordx4 v[28:31], v2, s[24:27], s58 offen
    s_add_u32 s58, s58, 131072
    s_waitcnt vmcnt(7)
    buffer_load_dwordx4 v[32:35], v2, s[24:27], s58 offen
    s_add_u32 s58, s58, 131072
    s_waitcnt vmcnt(7)
    buffer_load_dwordx4 v[36:39], v2, s[24:27], s58 offen
    s_add_u32 s58, s58, 131072
    s_cmp_lt_u32 s58, 4194304
    s_cbranch_scc1 P_W2
    s_mov_b32 s48, s58
    s_lshl_b32 s58, s36, 10
P_X:
    s_waitcnt vmcnt(7)
    buffer_load_dwordx4 v[8:11], v1, s[16:19], s58 offen
    s_add_u32 s58, s58, 16384
    s_waitcnt vmcnt(7)
    buffer_load_dwordx4 v[12:15], v1, s[16:19], s58 offen
    s_add_u32 s58, s58, 16384
    s_waitcnt vmcnt(7)
    buffer_load_dwordx4 v[16:19], v1, s[16:19], s58 offen
    s_add_u32 s58, s58, 16384
    s_waitcnt vmcnt(7)
    buffer_load_dwordx4 v[20:23], v1, s[16:19], s58 offen
    s_add_u32 s58, s58, 16384
    s_waitcnt vmcnt(7)
    buffer_load_dwordx4 v[24:27], v1, s[16:19], s58 offen
    s_add_u32 s58, s58, 16384
    s_waitcnt vmcnt(7)
    buffer_load_dwordx4 v[28:31], v1, s[16:19], s58 offen
    s_add_u32 s58, s58, 16384
    s_waitcnt vmcnt(7)
    buffer_load_dwordx4 v[32:35], v1, s[16:19], s58 offen
    s_add_u32 s58, s58, 16384
    s_waitcnt vmcnt(7)
    buffer_load_dwordx4 v[36:39], v1, s[16:19], s58 offen
    s_add_u32 s58, s58, 16384
    s_cmp_lt_u32 s58, 229376
    s_cbranch_scc1 P_X
    s_mov_b32 s58, s48
P_W3:
    s_waitcnt vmcnt(7)
    buffer_load_dwordx4 v[8:11], v2, s[24:27], s58 offen
    s_add_u32 s58, s58, 131072
    s_waitcnt vmcnt(7)
    buffer_load_dwordx4 v[12:15], v2, s[24:27], s58 offen
    s_add_u32 s58, s58, 131072
    s_waitcnt vmcnt(7)
    buffer_load_dwordx4 v[16:19], v2, s[24:27], s58 offen
    s_add_u32 s58, s58, 131072
    s_waitcnt vmcnt(7)
    buffer_load_dwordx4 v[20:23], v2, s[24:27], s58 offen
    s_add_u32 s58, s58, 131072
    s_waitcnt vmcnt(7)
    buffer_load_dwordx4 v[24:27], v2, s[24:27], s58 offen
    s_add_u32 s58, s58, 131072
    s_waitcnt vmcnt(7)
    buffer_load_dwordx4 v[28:31], v2, s[24:27], s58 offen
    s_add_u32 s58, s58, 131072
    s_waitcnt vmcnt(7)
    buffer_load_dwordx4 v[32:35], v2, s[24:27], s58 offen
    s_add_u32 s58, s58, 131072
    s_waitcnt vmcnt(7)
    buffer_load_dwordx4 v[36:39], v2, s[24:27], s58 offen
    s_add_u32 s58, s58, 131072
    s_cmp_lt_u32 s58, 7340032
    s_cbranch_scc1 P_W3
    s_lshl_b32 s58, s36, 12
    s_add_u32 s58, s58, 0x638000
    s_waitcnt vmcnt(4)
    buffer_load_dwordx4 v[8:11], v1, s[32:35], s58 offen offset:0 sc1
    buffer_load_dwordx4 v[12:15], v1, s[32:35], s58 offen offset:1024 sc1
    buffer_load_dwordx4 v[16:19], v1, s[32:35], s58 offen offset:2048 sc1
    buffer_load_dwordx4 v[20:23], v1, s[32:35], s58 offen offset:3072 sc1
    s_add_u32 s58, s58, 294912
    s_waitcnt vmcnt(4)
    buffer_load_dwordx4 v[24:27], v1, s[32:35], s58 offen offset:0 sc1
    buffer_load_dwordx4 v[28:31], v1, s[32:35], s58 offen offset:1024 sc1
    buffer_load_dwordx4 v[32:35], v1, s[32:35], s58 offen offset:2048 sc1
    buffer_load_dwordx4 v[36:39], v1, s[32:35], s58 offen offset:3072 sc1
    s_add_u32 s58, s58, 294912
    s_waitcnt vmcnt(4)
    buffer_load_dwordx4 v[8:11], v1, s[32:35], s58 offen offset:0 sc1
    buffer_load_dwordx4 v[12:15], v1, s[32:35], s58 offen offset:1024 sc1
    buffer_load_dwordx4 v[16:19], v1, s[32:35], s58 offen offset:2048 sc1
    buffer_load_dwordx4 v[20:23], v1, s[32:35], s58 offen offset:3072 sc1
    s_add_u32 s58, s58, 294912
    s_waitcnt vmcnt(4)
    buffer_load_dwordx4 v[24:27], v1, s[32:35], s58 offen offset:0 sc1
    buffer_load_dwordx4 v[28:31], v1, s[32:35], s58 offen offset:1024 sc1
    buffer_load_dwordx4 v[32:35], v1, s[32:35], s58 offen offset:2048 sc1
    buffer_load_dwordx4 v[36:39], v1, s[32:35], s58 offen offset:3072 sc1
    s_add_u32 s58, s58, 294912
    s_waitcnt vmcnt(4)
    buffer_load_dwordx4 v[8:11], v1, s[32:35], s58 offen offset:0 sc1
    buffer_load_dwordx4 v[12:15], v1, s[32:35], s58 offen offset:1024 sc1
    buffer_load_dwordx4 v[16:19], v1, s[32:35], s58 offen offset:2048 sc1
    buffer_load_dwordx4 v[20:23], v1, s[32:35], s58 offen offset:3072 sc1
    s_add_u32 s58, s58, 294912
    s_waitcnt vmcnt(4)
    buffer_load_dwordx4 v[24:27], v1, s[32:35], s58 offen offset:0 sc1
    buffer_load_dwordx4 v[28:31], v1, s[32:35], s58 offen offset:1024 sc1
    buffer_load_dwordx4 v[32:35], v1, s[32:35], s58 offen offset:2048 sc1
    buffer_load_dwordx4 v[36:39], v1, s[32:35], s58 offen offset:3072 sc1
    s_add_u32 s58, s58, 294912
    s_waitcnt vmcnt(4)
    buffer_load_dwordx4 v[8:11], v1, s[32:35], s58 offen offset:0 sc1
    buffer_load_dwordx4 v[12:15], v1, s[32:35], s58 offen offset:1024 sc1
    buffer_load_dwordx4 v[16:19], v1, s[32:35], s58 offen offset:2048 sc1
    buffer_load_dwordx4 v[20:23], v1, s[32:35], s58 offen offset:3072 sc1
    s_add_u32 s58, s58, 294912
    s_endpgm
CODE_END:
.section .rodata,"a"
.p2align 6
.amdhsa_kernel parallel_sum__linear_kernel_hedgehog__mixer_token_mlp__prompt_kernel
  .amdhsa_next_free_vgpr 256
  .amdhsa_next_free_sgpr 72
  .amdhsa_accum_offset 256
  .amdhsa_group_segment_fixed_size 0
  .amdhsa_kernarg_size 96
  .amdhsa_user_sgpr_count 2
  .amdhsa_user_sgpr_kernarg_segment_ptr 1
  .amdhsa_system_sgpr_workgroup_id_x 1
  .amdhsa_float_denorm_mode_32 3
.end_amdhsa_kernel
```
